```python
import torch

def _softmax(x, axis=-1):
    return torch.softmax(x, dim=axis)
def _gelu(x):
    return torch.nn.functional.gelu(x, approximate="tanh")
def _silu(x):
    return torch.nn.functional.silu(x)
def _sigmoid(x):
    return torch.sigmoid(x)
def _layernorm(x, axis=-1, eps=1e-5):
    m = x.mean(dim=axis, keepdim=True)
    v = x.var(dim=axis, keepdim=True, unbiased=False)
    return (x - m) / torch.sqrt(v + eps)
def _scatter_add(tgt, idx, src, axis=0):
    return tgt.clone().index_add_(axis, idx, src)
def _segment_sum(src, seg, n):
    out = torch.zeros((n,) + src.shape[1:], dtype=src.dtype)
    return out.index_add_(0, seg, src)
def _pad(x, pw):
    flat = tuple(v for pair in reversed(pw) for v in pair)
    return torch.nn.functional.pad(x, flat)

kernel_name = 'recurrent_scan__sliding_block_cached__dense_activation_squared_relu__decode'

def setup_inputs():

    _w = (lambda a: (lambda t: t.to(torch.bfloat16) if t.is_floating_point() else t)(torch.as_tensor(a)))
    def _A_setup():
        B, Sq, D = 4, 1, 512
        Hq, Hkv, Sk, Dh = 32, 8, 4096, 128
        assert Hq % Hkv == 0, (Hq, Hkv)
        return {
            "x": _w((lambda *s: torch.randn(*s, dtype=torch.bfloat16) * 0.05)(B, Sq, D)),
            "k_cache": _w((lambda *s: torch.randn(*s, dtype=torch.bfloat16) * 0.8)(B, Hkv, Sk, Dh)),
            "v_cache": _w((lambda *s: torch.randn(*s, dtype=torch.bfloat16) * 0.2)(B, Hkv, Sk, Dh)),
            "wq": _w((lambda *s: torch.randn(*s, dtype=torch.bfloat16) * 0.8)(D, Hq * Dh) * (D ** -0.5)),
            "wo": _w((lambda *s: torch.randn(*s, dtype=torch.bfloat16) * 0.2)(Hq * Dh, D) * ((Hq * Dh) ** -0.5)),
        }
    _A_in = _A_setup()

    def _B_setup():
        B, S, D, F = 4, 1, 512, 1792
        return {
            "x": _w((lambda *s: torch.randn(*s, dtype=torch.bfloat16) * 0.05)(B, S, D)),
            "w1": _w((lambda *s: torch.randn(*s, dtype=torch.bfloat16) * 0.1)(D, F)),
            "b1": _w((lambda *s: torch.randn(*s, dtype=torch.bfloat16) * 0.4)(F)),
            "w2": _w((lambda *s: torch.randn(*s, dtype=torch.bfloat16) * 0.1)(F, D)),
            "b2": _w((lambda *s: torch.randn(*s, dtype=torch.bfloat16) * 6.4)(D)),
        }
    _B_in = _B_setup()

    return {
        "A_x": _A_in["x"],
        "A_k_cache": _A_in["k_cache"],
        "A_v_cache": _A_in["v_cache"],
        "A_wq": _A_in["wq"],
        "A_wo": _A_in["wo"],
        "B_x": _B_in["x"],
        "B_w1": _B_in["w1"],
        "B_b1": _B_in["b1"],
        "B_w2": _B_in["w2"],
        "B_b2": _B_in["b2"],
    }

def reference(A_x, A_k_cache, A_v_cache, A_wq, A_wo, B_x, B_w1, B_b1, B_w2, B_b2):
    def _A_ref(x, k_cache, v_cache, wq, wo):
        B, Sq, D = x.shape
        Hq, Dh = 32, 128
        Hkv, Sk = k_cache.shape[1], k_cache.shape[2]
        W = min(4096, max(256, Sk // 4))
        rep = Hq // Hkv
        q = (lambda x, *d: x.permute(*d))((x @ wq).reshape(B, Sq, Hq, Dh), 0, 2, 1, 3)
        k = (lambda x, n, axis: torch.repeat_interleave(x, n, dim=axis))(k_cache[:, :, Sk - W:, :], rep, axis=1)
        v = (lambda x, n, axis: torch.repeat_interleave(x, n, dim=axis))(v_cache[:, :, Sk - W:, :], rep, axis=1)
        scores = torch.einsum("bhqd,bhkd->bhqk", q, k) * (Dh ** -0.5)
        p = _softmax(scores, axis=-1)
        o = torch.einsum("bhqk,bhkd->bhqd", p, v)
        return (lambda x, *d: x.permute(*d))(o, 0, 2, 1, 3).reshape(B, Sq, Hq * Dh) @ wo

    def _B_ref(x, w1, b1, w2, b2):
        h = torch.einsum("bsd,df->bsf", x, w1) + b1
        zero = torch.zeros_like(h)
        r = torch.where(h > zero, h, zero)
        h = r * r
        out = torch.einsum("bsf,fd->bsd", h, w2) + b2
        return out

    x = A_x
    xn = _layernorm(x, axis=-1)
    s = _A_ref(xn, A_k_cache, A_v_cache, A_wq, A_wo)
    g = _silu(_B_ref(xn, B_w1, B_b1, B_w2, B_b2))
    return x + s * g
```

```asm
; @launch grid=(256,1,1) block=(640,1,1) lds=131136
.amdgcn_target "amdgcn-amd-amdhsa--gfx950"
.text
.p2align 10
.fill 64, 4, 0xbf800000
.globl recurrent_scan__sliding_block_cached__dense_activation_squared_relu__decode_kernel
.p2align 8
.type recurrent_scan__sliding_block_cached__dense_activation_squared_relu__decode_kernel,@function
recurrent_scan__sliding_block_cached__dense_activation_squared_relu__decode_kernel:
    s_cmp_ge_u32 s2, 256
    s_cbranch_scc1 L_exit
    s_load_dwordx16 s[8:23], s[0:1], 0
    s_load_dwordx8 s[24:31], s[0:1], 64
    s_load_dwordx2 s[32:33], s[0:1], 96
    v_lshrrev_b32 v1, 6, v0
    v_and_b32 v0, 63, v0
    v_readfirstlane_b32 s3, v1
    s_and_b32 s4, s2, 7
    s_lshr_b32 s5, s2, 3
    s_movk_i32 s37, 0x3ff
    s_movk_i32 s98, 0xfc00
    s_cmp_lt_u32 s3, 4
    s_cbranch_scc0 L_notln
    v_lshlrev_b32 v12, 4, v0
    s_lshl_b32 s39, s3, 10
    v_lshrrev_b32 v3, 4, v0
    v_lshlrev_b32 v3, 1, v3
    v_and_b32 v2, 7, v0
    v_xor_b32 v2, v2, v3
    v_lshlrev_b32 v2, 4, v2
    v_lshrrev_b32 v3, 3, v0
    v_mul_u32_u24 v3, 8192, v3
    v_add_u32 v2, v2, v3
    s_lshr_b32 s7, s5, 3
    s_lshl_b32 s38, s7, 20
    s_lshl_b32 s56, s3, 18
    s_add_u32 s38, s38, s56
    s_lshl_b32 s56, s4, 10
    s_add_u32 s38, s38, s56
    s_and_b32 s56, s5, 7
    s_lshl_b32 s56, s56, 7
    s_add_u32 s38, s38, s56
    s_lshl_b32 s56, s3, 12
    s_mov_b32 s54, 4096
    s_mov_b32 s55, 0x20000
    s_mov_b32 s42, 0x400000
    s_mov_b32 s43, 0x20000
    s_waitcnt lgkmcnt(0)
    s_mov_b32 s52, s8
    s_mov_b32 s53, s9
    buffer_load_dwordx4 v[4:7], v12, s[52:55], s39 offen
    s_mov_b32 s40, s14
    s_mov_b32 s41, s15
    s_add_u32 m0, s56, 65536
    s_nop 0
    buffer_load_dwordx4 v2, s[40:43], s38 offen offset:0 nt lds
    s_add_u32 s38, s38, 64512
    buffer_load_dwordx4 v2, s[40:43], s38 offen offset:1024 nt lds
    s_add_u32 s38, s38, 64512
    buffer_load_dwordx4 v2, s[40:43], s38 offen offset:2048 nt lds
    s_add_u32 s38, s38, 64512
    buffer_load_dwordx4 v2, s[40:43], s38 offen offset:3072 nt lds
    s_barrier
    s_branch L_ln
L_notln:
    s_cmp_lt_u32 s3, 8
    s_cbranch_scc1 L_kv
    s_cmp_eq_u32 s3, 8
    s_cbranch_scc1 L_w8i
    s_waitcnt lgkmcnt(0)
    s_load_dword s34, s[32:33], 0
    s_barrier
    s_branch L_w9
L_w8i:
    s_getpc_b64 s[64:65]
L_pc:
    s_and_b32 s6, s5, 7
    s_mul_i32 s6, s6, 1536
    s_sub_u32 s6, s6, L_pc-recurrent_scan__sliding_block_cached__dense_activation_squared_relu__decode_kernel
    s_ashr_i32 s7, s6, 31
    s_add_u32 s64, s64, s6
    s_addc_u32 s65, s65, s7
    v_lshlrev_b32 v3, 6, v0
    s_mov_b64 exec, 0xffffff
    global_load_dword v125, v3, s[64:65]
    s_mov_b64 exec, -1
    v_lshlrev_b32 v3, 2, v0
    v_add_u32 v3, 128768, v3
    v_cmp_gt_u32 vcc, 16, v0
    s_nop 1
    v_cndmask_b32 v4, 0, -1, vcc
    ds_write_b32 v3, v4
    v_mov_b32 v4, 0
    s_mov_b64 exec, 0xffff
    ds_write_b32 v3, v4 offset:256
    s_mov_b64 exec, -1
    s_waitcnt lgkmcnt(0)
    s_load_dword s34, s[32:33], 0
    s_barrier
    s_branch L_w0
L_kv:
    s_sub_u32 s3, s3, 4
    v_lshrrev_b32 v8, 4, v0
    v_and_b32 v9, 15, v0
    v_xor_b32 v2, v9, v8
    v_lshlrev_b32 v2, 4, v2
    v_lshl_add_u32 v2, v8, 8, v2
    v_xor_b32 v3, 64, v2
    v_xor_b32 v4, 128, v2
    v_xor_b32 v5, 192, v2
    s_lshr_b32 s6, s5, 3
    s_and_b32 s7, s5, 7
    s_lshl_b32 s38, s6, 3
    s_add_u32 s38, s38, s4
    s_lshl_b32 s38, s38, 20
    s_lshl_b32 s56, s3, 10
    s_add_u32 s38, s38, s56
    s_add_u32 s38, s38, 786432
    s_lshl_b32 s56, s3, 13
    s_lshl_b32 s64, s7, 12
    s_mov_b32 s66, s38
    s_mov_b32 s42, 0x2000000
    s_mov_b32 s43, 0x20000
    s_waitcnt lgkmcnt(0)
    s_mov_b32 s40, s10
    s_mov_b32 s41, s11
    s_load_dword s34, s[32:33], 0
    s_barrier
    s_add_u32 m0, s56, 0
    s_add_u32 s39, s64, s66
    s_add_u32 s64, s64, 4096
    s_and_b32 s64, s64, 0x7000
    s_add_u32 s66, s66, 31744
    buffer_load_dwordx4 v2, s[40:43], s39 offen offset:0 nt lds
    s_add_u32 s39, s64, s66
    s_add_u32 s64, s64, 4096
    s_and_b32 s64, s64, 0x7000
    s_add_u32 s66, s66, 31744
    buffer_load_dwordx4 v3, s[40:43], s39 offen offset:1024 nt lds
    s_add_u32 s39, s64, s66
    s_add_u32 s64, s64, 4096
    s_and_b32 s64, s64, 0x7000
    s_add_u32 s66, s66, 31744
    buffer_load_dwordx4 v4, s[40:43], s39 offen offset:2048 nt lds
    s_add_u32 s39, s64, s66
    s_add_u32 s64, s64, 4096
    s_and_b32 s64, s64, 0x7000
    s_add_u32 s66, s66, 35840
    s_waitcnt vmcnt(2)
    buffer_load_dwordx4 v5, s[40:43], s39 offen offset:3072 nt lds
    s_add_u32 m0, s56, 4096
    s_add_u32 s39, s64, s66
    s_add_u32 s64, s64, 4096
    s_and_b32 s64, s64, 0x7000
    s_add_u32 s66, s66, 31744
    s_waitcnt vmcnt(2)
    buffer_load_dwordx4 v2, s[40:43], s39 offen offset:0 nt lds
    s_add_u32 s39, s64, s66
    s_add_u32 s64, s64, 4096
    s_and_b32 s64, s64, 0x7000
    s_add_u32 s66, s66, 31744
    s_waitcnt vmcnt(2)
    buffer_load_dwordx4 v3, s[40:43], s39 offen offset:1024 nt lds
    s_add_u32 s39, s64, s66
    s_add_u32 s64, s64, 4096
    s_and_b32 s64, s64, 0x7000
    s_add_u32 s66, s66, 31744
    s_waitcnt vmcnt(2)
    buffer_load_dwordx4 v4, s[40:43], s39 offen offset:2048 nt lds
    s_add_u32 s39, s64, s66
    s_add_u32 s64, s64, 4096
    s_and_b32 s64, s64, 0x7000
    s_add_u32 s66, s66, 35840
    s_waitcnt vmcnt(2)
    buffer_load_dwordx4 v5, s[40:43], s39 offen offset:3072 nt lds
    s_branch L_att
L_ln:
    s_lshr_b32 s7, s5, 3
    s_mul_i32 s68, s4, 3
    s_min_u32 s69, s4, 4
    s_add_u32 s68, s68, s69
    s_add_u32 s68, s68, s7
    s_cmp_lt_u32 s4, 4
    s_cselect_b32 s69, 4, 3
    s_cmp_lt_u32 s7, s69
    s_cselect_b32 s69, 1, 0
    s_mov_b32 s47, 0x20000
    s_mul_i32 s46, s69, 1835008
    v_lshrrev_b32 v3, 3, v0
    v_mul_u32_u24 v3, 4608, v3
    v_sub_u32 v2, v2, v3
    s_and_b32 s38, s5, 7
    s_lshl_b32 s38, s38, 2
    s_add_u32 s38, s38, s3
    s_mul_i32 s38, s38, 57344
    s_lshl_b32 s39, s68, 7
    s_add_u32 s38, s38, s39
L_pad0:
    s_cbranch_execz L_pad1
    s_lshl_b32 s56, s3, 11
    s_mov_b32 s44, s20
    s_mov_b32 s45, s21
    s_add_u32 m0, s56, 98304
    s_nop 0
    buffer_load_dwordx4 v2, s[44:47], s38 offen offset:0 nt lds
    s_add_u32 s38, s38, 27648
    buffer_load_dwordx4 v2, s[44:47], s38 offen offset:1024 nt lds
    s_load_dword s34, s[32:33], 0
    s_mov_b32 s48, s32
    s_mov_b32 s49, s33
    s_mov_b32 s50, 0x400000
    s_mov_b32 s51, 0x20000
    v_lshrrev_b32 v2, 2, v0
    v_lshlrev_b32 v2, 6, v2
    v_and_b32 v3, 1, v0
    v_lshl_add_u32 v2, v3, 5, v2
    v_and_b32 v3, 2, v0
    v_lshl_add_u32 v2, v3, 2, v2
    s_mul_i32 s38, s3, 1088
    s_add_u32 s38, s38, 114688
    v_add_u32 v2, s38, v2
    s_lshl_b32 s38, s3, 2
    s_add_u32 s38, s38, 128896
    v_mov_b32 v9, s38
    v_mov_b32 v10, 1
    v_mov_b32 v21, 0x3b000000
    s_waitcnt vmcnt(6)
    v_lshlrev_b32 v12, 16, v4
    v_and_b32 v13, 0xffff0000, v4
    v_lshlrev_b32 v14, 16, v5
    v_and_b32 v15, 0xffff0000, v5
    v_lshlrev_b32 v16, 16, v6
    v_and_b32 v17, 0xffff0000, v6
    v_lshlrev_b32 v18, 16, v7
    v_and_b32 v19, 0xffff0000, v7
    v_pk_add_f32 v[22:23], v[12:13], v[14:15]
    v_pk_add_f32 v[24:25], v[16:17], v[18:19]
    v_pk_add_f32 v[22:23], v[22:23], v[24:25]
    v_add_f32 v20, v22, v23
    s_nop 1
    v_add_f32_dpp v20, v20, v20 row_ror:8 row_mask:0xf bank_mask:0xf
    s_nop 1
    v_add_f32_dpp v20, v20, v20 row_ror:4 row_mask:0xf bank_mask:0xf
    s_nop 1
    v_add_f32_dpp v20, v20, v20 row_ror:2 row_mask:0xf bank_mask:0xf
    s_nop 1
    v_add_f32_dpp v20, v20, v20 row_ror:1 row_mask:0xf bank_mask:0xf
    s_nop 1
    v_add_f32_dpp v20, v20, v20 row_bcast:15 row_mask:0xa bank_mask:0xf
    s_nop 1
    v_add_f32_dpp v20, v20, v20 row_bcast:31 row_mask:0xc bank_mask:0xf
    s_nop 0
    v_readlane_b32 s38, v20, 63
    s_nop 1
    v_mul_f32 v20, s38, v21
    v_sub_f32 v24, v12, v20
    v_sub_f32 v25, v13, v20
    v_sub_f32 v26, v14, v20
    v_sub_f32 v27, v15, v20
    v_sub_f32 v28, v16, v20
    v_sub_f32 v29, v17, v20
    v_sub_f32 v30, v18, v20
    v_sub_f32 v31, v19, v20
    v_mul_f32 v22, v24, v24
    v_mul_f32 v23, v25, v25
    v_fmac_f32 v22, v26, v26
    v_fmac_f32 v23, v27, v27
    v_fmac_f32 v22, v28, v28
    v_fmac_f32 v23, v29, v29
    v_fmac_f32 v22, v30, v30
    v_fmac_f32 v23, v31, v31
    v_add_f32 v22, v22, v23
    s_nop 1
    v_add_f32_dpp v22, v22, v22 row_ror:8 row_mask:0xf bank_mask:0xf
    s_nop 1
    v_add_f32_dpp v22, v22, v22 row_ror:4 row_mask:0xf bank_mask:0xf
    s_nop 1
    v_add_f32_dpp v22, v22, v22 row_ror:2 row_mask:0xf bank_mask:0xf
    s_nop 1
    v_add_f32_dpp v22, v22, v22 row_ror:1 row_mask:0xf bank_mask:0xf
    s_nop 1
    v_add_f32_dpp v22, v22, v22 row_bcast:15 row_mask:0xa bank_mask:0xf
    s_nop 1
    v_add_f32_dpp v22, v22, v22 row_bcast:31 row_mask:0xc bank_mask:0xf
    s_nop 0
    v_readlane_b32 s38, v22, 63
    v_cvt_pk_bf16_f32 v20, v20, v20
    v_and_b32 v20, 0xffff0000, v20
    v_mul_f32 v22, s38, v21
    v_cvt_pk_bf16_f32 v22, v22, v22
    v_and_b32 v22, 0xffff0000, v22
    v_add_f32 v22, 0x3727c5ac, v22
    v_cvt_pk_bf16_f32 v22, v22, v22
    v_and_b32 v22, 0xffff0000, v22
    v_sqrt_f32 v22, v22
    v_sub_f32 v12, v12, v20
    v_sub_f32 v13, v13, v20
    v_sub_f32 v14, v14, v20
    v_sub_f32 v15, v15, v20
    v_sub_f32 v16, v16, v20
    v_sub_f32 v17, v17, v20
    v_sub_f32 v18, v18, v20
    v_sub_f32 v19, v19, v20
    v_cvt_pk_bf16_f32 v22, v22, v22
    v_and_b32 v22, 0xffff0000, v22
    v_rcp_f32 v22, v22
    v_cvt_pk_bf16_f32 v4, v12, v13
    v_cvt_pk_bf16_f32 v5, v14, v15
    v_cvt_pk_bf16_f32 v6, v16, v17
    v_cvt_pk_bf16_f32 v7, v18, v19
    v_lshlrev_b32 v12, 16, v4
    v_and_b32 v13, 0xffff0000, v4
    v_lshlrev_b32 v14, 16, v5
    v_and_b32 v15, 0xffff0000, v5
    v_lshlrev_b32 v16, 16, v6
    v_and_b32 v17, 0xffff0000, v6
    v_lshlrev_b32 v18, 16, v7
    v_and_b32 v19, 0xffff0000, v7
    v_mul_f32 v12, v12, v22
    v_mul_f32 v13, v13, v22
    v_mul_f32 v14, v14, v22
    v_mul_f32 v15, v15, v22
    v_mul_f32 v16, v16, v22
    v_mul_f32 v17, v17, v22
    v_mul_f32 v18, v18, v22
    v_mul_f32 v19, v19, v22
    v_cvt_pk_bf16_f32 v4, v12, v13
    v_cvt_pk_bf16_f32 v5, v14, v15
    v_cvt_pk_bf16_f32 v6, v16, v17
    v_cvt_pk_bf16_f32 v7, v18, v19
    ds_write2_b64 v2, v[4:5], v[6:7] offset0:0 offset1:2
    s_waitcnt vmcnt(2)
    ds_write_b32 v9, v10 offset:0
    s_waitcnt lgkmcnt(0)
    s_add_u32 s36, s34, 1
    s_and_b32 s35, s36, s37
    v_mov_b32 v11, s35
    s_branch L_ln_done
L_w9:
    s_lshr_b32 s60, s2, 4
    s_lshl_b32 s60, s60, 3
    s_add_u32 s60, s60, s4
    s_lshl_b32 s60, s60, 6
    s_and_b32 s61, s5, 1
    s_lshl_b32 s61, s61, 13
    s_sub_u32 s60, s60, s61
    s_add_u32 s60, s60, 16384
    s_mov_b32 s48, s32
    s_mov_b32 s49, s33
    s_mov_b32 s50, 0x400000
    s_mov_b32 s51, 0x20000
    s_waitcnt lgkmcnt(0)
    s_memtime s[90:91]
    s_waitcnt lgkmcnt(0)
    s_load_dword s61, s[32:33], s60
    s_waitcnt lgkmcnt(0)
    s_memtime s[94:95]
    s_add_u32 s62, s34, 1
    s_and_b32 s62, s62, 0x1fffff
    s_getreg_b32 s63, hwreg(HW_REG_XCC_ID, 0, 3)
    s_lshl_b32 s63, s63, 21
    s_or_b32 s62, s62, s63
    s_lshl_b32 s63, s4, 5
    s_add_u32 s63, s63, s5
    s_lshl_b32 s63, s63, 2
    s_add_u32 s63, s63, 2101248
    v_mov_b32 v21, 0
    s_waitcnt lgkmcnt(0)
    s_sub_u32 s94, s94, s90
    s_lshr_b32 s94, s94, 4
    s_min_u32 s94, s94, 160
    s_max_u32 s94, s94, 48
    s_lshl_b32 s94, s94, 24
    s_or_b32 s94, s94, s62
    v_mov_b32 v20, s94
    s_mov_b64 exec, 1
    buffer_store_dword v20, v21, s[48:51], s63 offen sc1
    s_lshr_b32 s60, s5, 3
    s_lshl_b32 s60, s60, 3
    s_add_u32 s60, s60, s4
    s_lshl_b32 s60, s60, 20
    s_add_u32 s60, s60, 786432
    s_lshl_b32 s61, s4, 19
    s_load_dword s64, s[16:17], s61
    s_load_dword s65, s[12:13], s60
L_chain0:
L_pad1:
    s_cbranch_execz L_pad2
    s_load_dword s66, s[24:25], 0
    s_load_dword s67, s[28:29], 0
    s_mov_b64 exec, 0
    s_branch L_chain1
L_w3b:
    s_waitcnt lgkmcnt(0)
    s_endpgm
L_w0:
    s_mov_b32 s48, s32
    s_mov_b32 s49, s33
    s_mov_b32 s50, 0x400000
    s_mov_b32 s51, 0x20000
    s_getreg_b32 s57, hwreg(HW_REG_XCC_ID, 0, 3)
    s_lshl_b32 s58, s4, 5
    s_add_u32 s58, s58, s5
    s_lshl_b32 s67, s58, 10
    s_add_u32 s56, s67, 32768
    v_lshlrev_b32 v1, 4, v0
    buffer_load_dwordx4 v[124:127], v1, s[48:51], s56 offen
    s_waitcnt lgkmcnt(0)
    s_add_u32 s36, s34, 1
    s_and_b32 s35, s36, s37
    v_mov_b32 v11, s35
    s_and_b32 s56, s36, 0x1fffff
    s_lshl_b32 s57, s57, 21
    s_or_b32 s57, s57, s56
    s_mov_b64 exec, 0
    s_branch L_chain0
L_w8b:
    s_mov_b64 exec, -1
    s_mov_b32 s52, s8
    s_mov_b32 s53, s9
    s_mov_b32 s54, 0x1000
    s_mov_b32 s55, 0x20000
    s_lshr_b32 s7, s5, 3
    s_mul_i32 s68, s4, 3
    s_min_u32 s69, s4, 4
    s_add_u32 s68, s68, s69
    s_add_u32 s68, s68, s7
    s_cmp_lt_u32 s4, 4
    s_cselect_b32 s69, 4, 3
    s_cmp_lt_u32 s7, s69
    s_cselect_b32 s69, 1, 0
    s_lshr_b32 s6, s5, 3
    s_and_b32 s7, s5, 7
    v_lshrrev_b32 v3, 3, v0
    v_and_b32 v3, 3, v3
    v_lshlrev_b32 v3, 5, v3
    v_lshrrev_b32 v4, 2, v0
    v_lshl_add_u32 v3, v4, 7, v3
    v_and_b32 v4, 3, v0
    v_lshl_add_u32 v4, v4, 3, v3
    v_add_u32 v4, 0x10000, v4
    v_xor_b32 v5, 32, v4
    v_xor_b32 v6, 64, v4
    v_xor_b32 v7, 96, v4
    v_bfe_u32 v10, v0, 2, 2
    v_mul_u32_u24 v8, 1088, v10
    v_lshrrev_b32 v9, 4, v0
    v_lshl_add_u32 v8, v9, 4, v8
    s_lshl_b32 s39, s6, 8
    s_add_u32 s39, s39, 114688
    v_add_u32 v8, s39, v8
    v_lshlrev_b32 v10, 11, v10
    v_lshl_add_u32 v10, v9, 6, v10
    v_and_b32 v9, 3, v0
    v_lshl_add_u32 v10, v9, 4, v10
    v_cmp_eq_u32 s[90:91], 1, v9
    v_cmp_eq_u32 s[92:93], 2, v9
    v_cmp_eq_u32 s[94:95], 3, v9
    s_lshl_b32 s38, s4, 15
    s_lshl_b32 s39, s6, 13
    s_add_u32 s38, s38, s39
    s_lshl_b32 s39, s7, 8
    s_add_u32 s38, s38, s39
    s_add_u32 s38, s38, 32768
    v_mov_b32 v2, 128896
    v_mov_b32 v9, 1
    s_mov_b32 s63, 0
L_lnw:
    ds_read_b128 v[12:15], v2 offset:0
    s_add_u32 s63, s63, 1
    s_cmp_gt_u32 s63, 4194304
    s_cbranch_scc1 L_lnwok
    s_waitcnt lgkmcnt(0)
    v_and_b32 v12, v12, v13
    v_and_b32 v14, v14, v15
    v_and_b32 v12, v12, v14
    v_cmp_eq_u32 vcc, 0, v12
    s_cbranch_vccnz L_lnw
L_lnwok:
    s_setprio 3
    ds_read_b128 v[12:15], v8 offset:0
    ds_read_b64_tr_b16 v[60:61], v4 offset:0
    ds_read_b64_tr_b16 v[62:63], v4 offset:2048
    ds_read_b64_tr_b16 v[64:65], v5 offset:0
    ds_read_b64_tr_b16 v[66:67], v5 offset:2048
    ds_read_b64_tr_b16 v[68:69], v6 offset:0
    ds_read_b64_tr_b16 v[70:71], v6 offset:2048
    ds_read_b64_tr_b16 v[72:73], v7 offset:0
    ds_read_b64_tr_b16 v[74:75], v7 offset:2048
    ds_read_b128 v[16:19], v8 offset:64
    ds_read_b64_tr_b16 v[76:77], v4 offset:4096
    ds_read_b64_tr_b16 v[78:79], v4 offset:6144
    ds_read_b64_tr_b16 v[80:81], v5 offset:4096
    ds_read_b64_tr_b16 v[82:83], v5 offset:6144
    ds_read_b64_tr_b16 v[84:85], v6 offset:4096
    ds_read_b64_tr_b16 v[86:87], v6 offset:6144
    ds_read_b64_tr_b16 v[88:89], v7 offset:4096
    ds_read_b64_tr_b16 v[90:91], v7 offset:6144
    s_waitcnt lgkmcnt(9)
    v_mfma_f32_16x16x32_bf16 v[44:47], v[60:63], v[12:15], 0
    v_mfma_f32_16x16x32_bf16 v[48:51], v[64:67], v[12:15], 0
    v_mfma_f32_16x16x32_bf16 v[52:55], v[68:71], v[12:15], 0
    v_mfma_f32_16x16x32_bf16 v[56:59], v[72:75], v[12:15], 0
    ds_read_b128 v[20:23], v8 offset:128
    ds_read_b64_tr_b16 v[92:93], v4 offset:8192
    ds_read_b64_tr_b16 v[94:95], v4 offset:10240
    ds_read_b64_tr_b16 v[96:97], v5 offset:8192
    ds_read_b64_tr_b16 v[98:99], v5 offset:10240
    ds_read_b64_tr_b16 v[100:101], v6 offset:8192
    ds_read_b64_tr_b16 v[102:103], v6 offset:10240
    ds_read_b64_tr_b16 v[104:105], v7 offset:8192
    ds_read_b64_tr_b16 v[106:107], v7 offset:10240
    s_waitcnt lgkmcnt(9)
    v_mfma_f32_16x16x32_bf16 v[44:47], v[76:79], v[16:19], v[44:47]
    v_mfma_f32_16x16x32_bf16 v[48:51], v[80:83], v[16:19], v[48:51]
    v_mfma_f32_16x16x32_bf16 v[52:55], v[84:87], v[16:19], v[52:55]
    v_mfma_f32_16x16x32_bf16 v[56:59], v[88:91], v[16:19], v[56:59]
    ds_read_b128 v[24:27], v8 offset:192
    ds_read_b64_tr_b16 v[108:109], v4 offset:12288
    ds_read_b64_tr_b16 v[110:111], v4 offset:14336
    ds_read_b64_tr_b16 v[112:113], v5 offset:12288
    ds_read_b64_tr_b16 v[114:115], v5 offset:14336
    ds_read_b64_tr_b16 v[116:117], v6 offset:12288
    ds_read_b64_tr_b16 v[118:119], v6 offset:14336
    ds_read_b64_tr_b16 v[120:121], v7 offset:12288
    ds_read_b64_tr_b16 v[122:123], v7 offset:14336
    s_waitcnt lgkmcnt(9)
    v_mfma_f32_16x16x32_bf16 v[44:47], v[92:95], v[20:23], v[44:47]
    v_mfma_f32_16x16x32_bf16 v[48:51], v[96:99], v[20:23], v[48:51]
    v_mfma_f32_16x16x32_bf16 v[52:55], v[100:103], v[20:23], v[52:55]
    v_mfma_f32_16x16x32_bf16 v[56:59], v[104:107], v[20:23], v[56:59]
    s_waitcnt lgkmcnt(6)
    v_mfma_f32_16x16x32_bf16 v[44:47], v[108:111], v[24:27], v[44:47]
    s_waitcnt lgkmcnt(4)
    v_mfma_f32_16x16x32_bf16 v[48:51], v[112:115], v[24:27], v[48:51]
    s_waitcnt lgkmcnt(2)
    v_mfma_f32_16x16x32_bf16 v[52:55], v[116:119], v[24:27], v[52:55]
    s_waitcnt lgkmcnt(0)
    v_mfma_f32_16x16x32_bf16 v[56:59], v[120:123], v[24:27], v[56:59]
    s_nop 3
    v_cndmask_b32 v28, v44, v48, s[90:91]
    v_cndmask_b32 v29, v45, v49, s[90:91]
    v_cndmask_b32 v30, v46, v50, s[90:91]
    v_cndmask_b32 v31, v47, v51, s[90:91]
    v_cndmask_b32 v28, v28, v52, s[92:93]
    v_cndmask_b32 v29, v29, v53, s[92:93]
    v_cndmask_b32 v30, v30, v54, s[92:93]
    v_cndmask_b32 v31, v31, v55, s[92:93]
    v_cndmask_b32 v28, v28, v56, s[94:95]
    v_cndmask_b32 v29, v29, v57, s[94:95]
    v_cndmask_b32 v30, v30, v58, s[94:95]
    v_cndmask_b32 v31, v31, v59, s[94:95]
    v_bfi_b32 v28, s37, v11, v28
    v_bfi_b32 v29, s37, v11, v29
    v_bfi_b32 v30, s37, v11, v30
L_pad2:
    s_cbranch_execz L_pad3
    v_bfi_b32 v31, s37, v11, v31
    buffer_store_dwordx4 v[28:31], v10, s[48:51], s38 offen
    ds_write_b32 v2, v9 offset:20
    s_setprio 0
    s_mov_b32 s97, 0
    s_lshl_b32 s56, s67, 1
    s_add_u32 s56, s56, 524288
    buffer_load_dwordx4 v[124:127], v1, s[48:51], s56 offen
    buffer_load_dwordx4 v[124:127], v1, s[48:51], s56 offen offset:1024
    s_lshl_b32 s56, s68, 3
    s_add_u32 s56, s56, s7
    s_lshl_b32 s56, s56, 10
    s_add_u32 s56, s56, 294912
    s_lshr_b32 s59, s67, 4
    s_add_u32 s59, s59, 2113536
    s_cmp_eq_u32 s69, 0
    s_cselect_b32 s56, s59, s56
    buffer_load_dwordx4 v[124:127], v1, s[48:51], s56 offen
    s_mov_b64 exec, 15
    buffer_load_dwordx4 v[124:127], v1, s[48:51], s59 offen
    s_mov_b64 exec, -1
    v_lshrrev_b32 v12, 4, v0
    v_bfe_u32 v13, v0, 2, 2
    v_and_b32 v14, 3, v0
    v_lshlrev_b32 v12, 6, v12
    v_lshl_add_u32 v12, v13, 8, v12
    v_lshl_add_u32 v12, v14, 4, v12
    v_add_u32 v13, 122368, v1
    s_lshl_b32 s56, s68, 3
    s_add_u32 s56, s56, s7
    s_lshl_b32 s56, s56, 10
    s_add_u32 s56, s56, 294912
    s_cmp_eq_u32 s69, 0
    s_cbranch_scc1 L_nohp
L_hw:
    s_sleep 1
    ds_read_b32 v14, v2 offset:24
    s_add_u32 s63, s63, 1
    s_cmp_gt_u32 s63, 4194304
    s_cbranch_scc1 L_hwok
    s_waitcnt lgkmcnt(0)
    v_cmp_eq_u32 vcc, 0, v14
    s_cbranch_vccnz L_hw
L_hwok:
    ds_read_b128 v[32:35], v13
    s_waitcnt lgkmcnt(0)
    buffer_store_dwordx4 v[32:35], v12, s[48:51], s56 offen
L_nohp:
L_xg:
    s_sleep 1
    ds_read_b32 v14, v2 offset:96
    s_add_u32 s63, s63, 1
    s_cmp_gt_u32 s63, 4194304
    s_cbranch_scc1 L_xgok
    s_waitcnt lgkmcnt(0)
    v_cmp_eq_u32 vcc, 0, v14
    s_cbranch_vccnz L_xg
L_xgok:
    s_mov_b32 s58, 2101248
    v_mov_b32 v24, s57
    s_lshl_b32 s60, s4, 3
    s_lshl_b64 s[60:61], 0xff, s60
L_xc:
    buffer_load_dwordx4 v[20:23], v1, s[48:51], s58 offen sc1
    s_add_u32 s97, s97, 1
    s_cmp_gt_u32 s97, 262144
    s_cbranch_scc1 L_xcok
    s_waitcnt vmcnt(0)
    v_bitop3_b32 v25, v20, v21, v24 bitop3:0x7e
    v_bitop3_b32 v26, v22, v23, v24 bitop3:0x7e
    v_or_b32 v25, v25, v26
    v_lshlrev_b32 v26, 11, v25
    v_cmp_ne_u32 vcc, 0, v26
    s_and_b64 s[64:65], vcc, s[60:61]
    s_cbranch_scc0 L_xcok
    s_sleep 4
    s_branch L_xc
L_xcok:
    v_lshlrev_b32 v26, 8, v25
    v_cmp_ne_u32 s[64:65], 0, v26
    s_and_b64 s[64:65], s[64:65], s[60:61]
    s_cselect_b32 s59, 2, 1
    s_cmp_eq_u32 s59, 1
    s_cbranch_scc1 L_xcl
    buffer_store_dwordx4 v[28:31], v10, s[48:51], s38 offen sc1
    s_cmp_eq_u32 s69, 0
    s_cbranch_scc1 L_xcl
    buffer_store_dwordx4 v[32:35], v12, s[48:51], s56 offen sc1
L_xcl:
    v_mov_b32 v26, s59
    ds_write_b32 v2, v26 offset:16
    s_mov_b32 s97, 0
    s_cbranch_vccz L_pbok
L_pb:
    s_add_u32 s97, s97, 1
    s_cmp_gt_u32 s97, 262144
    s_cbranch_scc1 L_pbok
    s_sleep 8
    buffer_load_dwordx4 v[20:23], v1, s[48:51], s58 offen sc1
    s_waitcnt vmcnt(0)
    v_bitop3_b32 v25, v20, v21, v24 bitop3:0x7e
    v_bitop3_b32 v26, v22, v23, v24 bitop3:0x7e
    v_or_b32 v25, v25, v26
    v_lshlrev_b32 v26, 11, v25
    v_cmp_ne_u32 vcc, 0, v26
    s_cbranch_vccnz L_pb
L_pbok:
    v_lshrrev_b32 v20, 24, v20
    v_lshrrev_b32 v21, 24, v21
    v_lshrrev_b32 v22, 24, v22
    v_lshrrev_b32 v23, 24, v23
    v_add_u32 v20, v20, v22
    v_add_u32 v21, v21, v23
    v_sub_u32 v20, v20, v21
    s_nop 1
    v_add_u32_dpp v20, v20, v20 row_ror:8 row_mask:0xf bank_mask:0xf
    s_nop 1
    v_add_u32_dpp v20, v20, v20 row_ror:4 row_mask:0xf bank_mask:0xf
    s_nop 1
    v_add_u32_dpp v20, v20, v20 row_ror:2 row_mask:0xf bank_mask:0xf
    s_nop 1
    v_add_u32_dpp v20, v20, v20 row_ror:1 row_mask:0xf bank_mask:0xf
    s_nop 1
    v_add_u32_dpp v20, v20, v20 row_bcast:15 row_mask:0xa bank_mask:0xf
    s_nop 0
    v_readlane_b32 s60, v20, 31
    v_readlane_b32 s61, v20, 63
    s_nop 2
    s_cmp_gt_i32 s60, s61
    s_cselect_b32 s96, 0x10f, 0
    s_cselect_b32 s61, 0, 0x1f0
    s_or_b32 s96, s96, s61
    v_mov_b32 v20, s96
    ds_write_b32 v2, v20 offset:28
    s_branch L_w8
L_att:
    s_mov_b32 s48, s32
    s_mov_b32 s49, s33
    s_mov_b32 s50, 0x400000
    s_mov_b32 s51, 0x20000
    s_mov_b32 s52, s16
    s_mov_b32 s53, s17
    s_mov_b32 s54, 0x400000
    s_mov_b32 s55, 0x20000
    v_lshrrev_b32 v10, 4, v0
    v_lshlrev_b32 v10, 1, v10
    v_and_b32 v1, 7, v0
    v_xor_b32 v1, v1, v10
    v_lshlrev_b32 v1, 4, v1
    v_lshrrev_b32 v10, 3, v0
    v_mul_u32_u24 v10, 1024, v10
    v_add_u32 v1, v1, v10
    s_lshl_b32 s60, s4, 2
    s_add_u32 s60, s60, s6
    s_lshl_b32 s60, s60, 17
    s_lshl_b32 s61, s3, 15
    s_add_u32 s60, s60, s61
    s_xor_b32 s62, s7, 4
    s_lshl_b32 s62, s62, 7
    s_add_u32 s93, s60, s62
    s_xor_b32 s62, s62, 768
    s_lshl_b32 s65, s3, 12
    v_mov_b32 v17, 128896
    s_lshl_b32 s60, s3, 2
    v_add_u32 v18, s60, v17
    v_mov_b32 v19, 1
    s_waitcnt vmcnt(2)
    ds_write_b32 v18, v19 offset:112
    s_add_u32 m0, s65, 81920
    s_waitcnt vmcnt(3)
    buffer_load_dwordx4 v1, s[52:55], s93 offen offset:0 nt lds
    s_mov_b32 s60, s7
    s_lshr_b32 s7, s5, 3
    s_mul_i32 s68, s4, 3
    s_min_u32 s69, s4, 4
    s_add_u32 s68, s68, s69
    s_add_u32 s68, s68, s7
    s_cmp_lt_u32 s4, 4
    s_cselect_b32 s69, 4, 3
    s_cmp_lt_u32 s7, s69
    s_cselect_b32 s69, 1, 0
    s_add_u32 s93, s93, 7168
    s_waitcnt vmcnt(3)
    buffer_load_dwordx4 v1, s[52:55], s93 offen offset:1024 nt lds
    s_mov_b32 s7, s60
    s_mov_b32 s44, s24
    s_mov_b32 s45, s25
    s_mul_i32 s46, s69, 1835008
    s_mov_b32 s47, 0x20000
    s_lshl_b32 s68, s68, 2
    s_add_u32 s68, s68, s3
    s_lshl_b32 s68, s68, 14
    s_add_u32 s68, s68, s62
    s_lshl_b32 s69, s3, 11
    s_add_u32 s93, s93, 7168
    s_waitcnt vmcnt(3)
    buffer_load_dwordx4 v1, s[52:55], s93 offen offset:2048 nt lds
    v_lshlrev_b32 v6, 1, v8
    v_xor_b32 v6, v9, v6
    v_lshlrev_b32 v6, 4, v6
    v_lshl_add_u32 v6, v8, 8, v6
    v_xor_b32 v7, 128, v6
    v_mov_b32 v17, 128896
L_pad3:
    s_cbranch_execz L_w8b
    s_lshl_b32 s60, s3, 2
    v_add_u32 v18, s60, v17
    v_mov_b32 v19, 1
    v_lshrrev_b32 v25, 2, v0
    s_add_u32 s93, s93, 7168
    s_waitcnt vmcnt(3)
    buffer_load_dwordx4 v1, s[52:55], s93 offen offset:3072 nt lds
    v_and_b32 v26, 7, v25
    v_lshlrev_b32 v26, 5, v26
    v_lshl_add_u32 v26, v25, 8, v26
    v_and_b32 v14, 3, v0
    v_lshl_add_u32 v14, v14, 3, v26
    s_lshl_b32 s60, s3, 6
    v_xor_b32 v14, s60, v14
    v_xor_b32 v15, 32, v14
    v_bfe_u32 v25, v0, 2, 2
    v_lshlrev_b32 v28, 6, v25
    s_waitcnt vmcnt(4)
    ds_write_b32 v18, v19 offset:96
    s_mov_b32 s40, s12
    s_mov_b32 s41, s13
    s_mov_b32 s66, s38
    s_add_u32 m0, s56, 32768
    s_add_u32 s39, s64, s66
    s_add_u32 s64, s64, 4096
    s_and_b32 s64, s64, 0x7000
    s_add_u32 s66, s66, 31744
    s_waitcnt vmcnt(3)
    buffer_load_dwordx4 v6, s[40:43], s39 offen offset:0 nt lds
    v_lshl_add_u32 v28, v8, 4, v28
    v_add_u32 v28, 120320, v28
    v_lshlrev_b32 v30, 14, v25
    v_lshl_add_u32 v30, v8, 5, v30
    v_and_b32 v16, 1, v0
    v_lshl_add_u32 v30, v16, 4, v30
    s_lshl_b32 s61, s4, 5
    s_add_u32 s61, s61, s7
    s_lshl_b32 s61, s61, 2
    s_add_u32 s61, s61, s6
    s_add_u32 s39, s64, s66
    s_add_u32 s64, s64, 4096
    s_and_b32 s64, s64, 0x7000
    s_add_u32 s66, s66, 31744
    s_waitcnt vmcnt(3)
    buffer_load_dwordx4 v7, s[40:43], s39 offen offset:1024 nt lds
    s_lshl_b32 s61, s61, 2
    s_add_u32 s61, s61, s3
    s_lshl_b32 s61, s61, 7
    s_add_u32 s61, s61, 524288
    v_mov_b32 v80, 0
    v_mov_b32 v81, 0
    v_mov_b32 v82, 0
    v_mov_b32 v83, 0
    v_mov_b32 v84, 0
    v_mov_b32 v85, 0
    s_add_u32 s39, s64, s66
    s_add_u32 s64, s64, 4096
    s_and_b32 s64, s64, 0x7000
    s_add_u32 s66, s66, 31744
    s_waitcnt vmcnt(3)
    buffer_load_dwordx4 v6, s[40:43], s39 offen offset:2048 nt lds
    v_mov_b32 v86, 0
    v_mov_b32 v87, 0
    v_mov_b32 v88, 0
    v_mov_b32 v89, 0
    v_mov_b32 v90, 0
    v_mov_b32 v91, 0
    v_mov_b32 v92, 0
    v_mov_b32 v93, 0
    v_mov_b32 v94, 0
    v_mov_b32 v95, 0
    s_add_u32 s39, s64, s66
    s_add_u32 s64, s64, 4096
    s_and_b32 s64, s64, 0x7000
    s_add_u32 s66, s66, 35840
    s_waitcnt vmcnt(3)
    buffer_load_dwordx4 v7, s[40:43], s39 offen offset:3072 nt lds
    v_mov_b32 v96, 0
    v_mov_b32 v97, 0
    v_mov_b32 v98, 0
    v_mov_b32 v99, 0
    v_mov_b32 v100, 0
    v_mov_b32 v101, 0
    v_mov_b32 v102, 0
    v_mov_b32 v103, 0
    v_mov_b32 v104, 0
    v_mov_b32 v105, 0
    s_add_u32 m0, s56, 36864
    s_add_u32 s39, s64, s66
    s_add_u32 s64, s64, 4096
    s_and_b32 s64, s64, 0x7000
    s_add_u32 s66, s66, 31744
    s_waitcnt vmcnt(7)
    buffer_load_dwordx4 v6, s[40:43], s39 offen offset:0 nt lds
    v_mov_b32 v106, 0
    v_mov_b32 v107, 0
    v_mov_b32 v108, 0
    v_mov_b32 v109, 0
    v_mov_b32 v110, 0
    v_mov_b32 v111, 0
    s_mov_b32 s63, 0
    s_mov_b32 s97, 0
    s_waitcnt lgkmcnt(0)
    s_add_u32 s36, s34, 1
    s_add_u32 s39, s64, s66
    s_add_u32 s64, s64, 4096
    s_and_b32 s64, s64, 0x7000
    s_add_u32 s66, s66, 31744
    s_waitcnt vmcnt(7)
    buffer_load_dwordx4 v7, s[40:43], s39 offen offset:1024 nt lds
    s_and_b32 s35, s36, s37
    v_mov_b32 v31, s35
    s_waitcnt vmcnt(6)
    ds_write_b32 v18, v19 offset:128
    s_add_u32 s39, s64, s66
    s_add_u32 s64, s64, 4096
    s_and_b32 s64, s64, 0x7000
    s_add_u32 s66, s66, 31744
    s_waitcnt vmcnt(7)
    buffer_load_dwordx4 v6, s[40:43], s39 offen offset:2048 nt lds
    s_add_u32 s39, s64, s66
    s_add_u32 s64, s64, 4096
    s_and_b32 s64, s64, 0x7000
    s_add_u32 s66, s66, 35840
    s_waitcnt vmcnt(7)
    buffer_load_dwordx4 v7, s[40:43], s39 offen offset:3072 nt lds
    s_add_u32 m0, s69, 106496
    s_waitcnt vmcnt(7)
    buffer_load_dwordx4 v1, s[44:47], s68 offen offset:0 nt lds
    s_add_u32 s68, s68, 7168
    s_waitcnt vmcnt(7)
    buffer_load_dwordx4 v1, s[44:47], s68 offen offset:1024 nt lds
L_px:
    ds_read_b128 v[36:39], v17 offset:80
    ds_read_b32 v46, v17 offset:16
    s_add_u32 s63, s63, 1
    s_cmp_gt_u32 s63, 4194304
    s_cbranch_scc1 L_pxok
    s_waitcnt lgkmcnt(0)
    v_and_b32 v36, v36, v37
    v_and_b32 v38, v38, v39
    v_and_b32 v36, v36, v38
    v_cmp_eq_u32 vcc, 0, v36
    s_cbranch_vccnz L_px
L_pxok:
    s_mov_b32 exec_lo, 0x55555555
    s_mov_b32 exec_hi, 0x55555555
    ds_read_b128 v[80:83], v28 offset:0
    ds_read_b128 v[84:87], v28 offset:256
    ds_read_b128 v[88:91], v28 offset:512
    ds_read_b128 v[92:95], v28 offset:768
    s_not_b64 exec, exec
    ds_read_b128 v[96:99], v28 offset:0
    ds_read_b128 v[100:103], v28 offset:256
    ds_read_b128 v[104:107], v28 offset:512
    ds_read_b128 v[108:111], v28 offset:768
    s_mov_b64 exec, -1
    v_readfirstlane_b32 s59, v46
    s_waitcnt vmcnt(6)
    ds_write_b32 v18, v19 offset:144
L_v1:
    ds_read_b128 v[36:39], v17 offset:144
    s_add_u32 s63, s63, 1
    s_cmp_gt_u32 s63, 4194304
    s_cbranch_scc1 L_v1ok
    s_waitcnt lgkmcnt(0)
    v_and_b32 v36, v36, v37
    v_and_b32 v38, v38, v39
    v_and_b32 v36, v36, v38
    v_cmp_eq_u32 vcc, 0, v36
    s_cbranch_vccnz L_v1
L_v1ok:
    ds_read_b64_tr_b16 v[48:49], v14 offset:32768
    ds_read_b64_tr_b16 v[52:53], v15 offset:32768
    ds_read_b64_tr_b16 v[56:57], v14 offset:40960
    ds_read_b64_tr_b16 v[60:61], v15 offset:40960
    ds_read_b64_tr_b16 v[64:65], v14 offset:49152
    ds_read_b64_tr_b16 v[68:69], v15 offset:49152
    ds_read_b64_tr_b16 v[72:73], v14 offset:57344
    ds_read_b64_tr_b16 v[76:77], v15 offset:57344
    s_waitcnt vmcnt(2) lgkmcnt(0)
    s_cmp_eq_u32 s59, 1
    s_setprio 3
    s_barrier
L_chain1:
L_pad4:
    s_cbranch_execz L_pad5
    ds_read_b64_tr_b16 v[50:51], v14 offset:36864
    ds_read_b64_tr_b16 v[54:55], v15 offset:36864
    ds_read_b64_tr_b16 v[58:59], v14 offset:45056
    ds_read_b64_tr_b16 v[62:63], v15 offset:45056
    ds_read_b64_tr_b16 v[66:67], v14 offset:53248
    ds_read_b64_tr_b16 v[70:71], v15 offset:53248
    ds_read_b64_tr_b16 v[74:75], v14 offset:61440
    ds_read_b64_tr_b16 v[78:79], v15 offset:61440
    s_waitcnt lgkmcnt(7)
    v_mfma_f32_16x16x32_bf16 v[36:39], v[48:51], v[80:83], 0
    s_waitcnt lgkmcnt(6)
    v_mfma_f32_16x16x32_bf16 v[36:39], v[52:55], v[96:99], v[36:39]
    s_waitcnt lgkmcnt(5)
    v_mfma_f32_16x16x32_bf16 v[36:39], v[56:59], v[84:87], v[36:39]
    s_waitcnt lgkmcnt(4)
    v_mfma_f32_16x16x32_bf16 v[36:39], v[60:63], v[100:103], v[36:39]
    s_waitcnt lgkmcnt(3)
    v_mfma_f32_16x16x32_bf16 v[36:39], v[64:67], v[88:91], v[36:39]
    s_waitcnt lgkmcnt(2)
    v_mfma_f32_16x16x32_bf16 v[36:39], v[68:71], v[104:107], v[36:39]
    s_waitcnt lgkmcnt(1)
    v_mfma_f32_16x16x32_bf16 v[36:39], v[72:75], v[92:95], v[36:39]
    s_waitcnt lgkmcnt(0)
    v_mfma_f32_16x16x32_bf16 v[36:39], v[76:79], v[108:111], v[36:39]
    s_mov_b32 exec_lo, 0x33333333
    s_mov_b32 exec_hi, 0x33333333
    s_nop 4
    s_cbranch_scc0 L_opub_rem
    v_bfi_b32 v36, s37, v31, v36
    v_bfi_b32 v37, s37, v31, v37
    v_bfi_b32 v38, s37, v31, v38
    v_bfi_b32 v39, s37, v31, v39
    buffer_store_dwordx4 v[36:39], v30, s[48:51], s61 offen
    ds_write_b32 v18, v19 offset:160
    s_waitcnt vmcnt(1)
    ds_write_b32 v18, v19 offset:32
    s_endpgm
L_opub_rem:
    v_bfi_b32 v36, s37, v31, v36
    v_bfi_b32 v37, s37, v31, v37
    v_bfi_b32 v38, s37, v31, v38
    v_bfi_b32 v39, s37, v31, v39
    buffer_store_dwordx4 v[36:39], v30, s[48:51], s61 offen sc1
    ds_write_b32 v18, v19 offset:160
    s_waitcnt vmcnt(1)
    ds_write_b32 v18, v19 offset:32
    s_endpgm
L_ln_done:
    v_lshrrev_b32 v3, 3, v0
    v_and_b32 v3, 3, v3
    v_lshlrev_b32 v3, 5, v3
    v_lshrrev_b32 v4, 2, v0
    v_lshl_add_u32 v3, v4, 7, v3
    v_and_b32 v4, 3, v0
    v_lshl_add_u32 v4, v4, 3, v3
    v_add_u32 v4, 0x10000, v4
    v_xor_b32 v5, 32, v4
    v_xor_b32 v6, 64, v4
    v_xor_b32 v7, 96, v4
    v_mov_b32 v17, 128896
    s_mov_b32 s63, 0
    s_waitcnt vmcnt(0)
    ds_write_b32 v9, v10 offset:64
    s_cmp_eq_u32 s3, 1
    s_cbranch_scc0 L_qk
    s_cmp_eq_u32 s69, 0
    s_cbranch_scc1 L_qk
    s_and_b32 s6, s5, 7
    v_and_b32 v15, 3, v0
    v_cmp_eq_u32 s[90:91], 1, v15
    v_cmp_eq_u32 s[92:93], 2, v15
    v_cmp_eq_u32 s[94:95], 3, v15
    v_lshrrev_b32 v13, 4, v0
    v_bfe_u32 v16, v0, 2, 2
    v_mul_u32_u24 v14, 1088, v16
    v_lshl_add_u32 v14, v13, 4, v14
    s_lshl_b32 s39, s6, 7
    s_add_u32 s39, s39, 114688
    v_add_u32 v14, s39, v14
    v_lshlrev_b32 v13, 4, v0
    v_add_u32 v13, 122368, v13
L_w1w:
    s_sleep 1
    ds_read_b128 v[20:23], v17 offset:64
    s_add_u32 s63, s63, 1
    s_cmp_gt_u32 s63, 4194304
    s_cbranch_scc1 L_w1wok
    s_waitcnt lgkmcnt(0)
    v_and_b32 v20, v20, v21
    v_and_b32 v22, v22, v23
    v_and_b32 v20, v20, v22
    v_cmp_eq_u32 vcc, 0, v20
    s_cbranch_vccnz L_w1w
L_w1wok:
    ds_read_b128 v[80:83], v14
    ds_read_b128 v[84:87], v14 offset:64
    ds_read_b64_tr_b16 v[24:25], v4 offset:32768
    ds_read_b64_tr_b16 v[26:27], v4 offset:34816
    ds_read_b64_tr_b16 v[28:29], v5 offset:32768
    ds_read_b64_tr_b16 v[30:31], v5 offset:34816
    ds_read_b64_tr_b16 v[32:33], v6 offset:32768
    ds_read_b64_tr_b16 v[34:35], v6 offset:34816
    ds_read_b64_tr_b16 v[36:37], v7 offset:32768
    ds_read_b64_tr_b16 v[38:39], v7 offset:34816
    ds_read_b64_tr_b16 v[40:41], v4 offset:36864
    ds_read_b64_tr_b16 v[42:43], v4 offset:38912
    ds_read_b64_tr_b16 v[44:45], v5 offset:36864
    ds_read_b64_tr_b16 v[46:47], v5 offset:38912
    ds_read_b64_tr_b16 v[48:49], v6 offset:36864
    ds_read_b64_tr_b16 v[50:51], v6 offset:38912
    ds_read_b64_tr_b16 v[52:53], v7 offset:36864
    ds_read_b64_tr_b16 v[54:55], v7 offset:38912
    s_waitcnt lgkmcnt(14)
    v_mfma_f32_16x16x32_bf16 v[64:67], v[24:27], v[80:83], 0
    s_waitcnt lgkmcnt(12)
    v_mfma_f32_16x16x32_bf16 v[68:71], v[28:31], v[80:83], 0
    s_waitcnt lgkmcnt(10)
    v_mfma_f32_16x16x32_bf16 v[72:75], v[32:35], v[80:83], 0
    s_waitcnt lgkmcnt(8)
    v_mfma_f32_16x16x32_bf16 v[76:79], v[36:39], v[80:83], 0
    s_waitcnt lgkmcnt(6)
    v_mfma_f32_16x16x32_bf16 v[64:67], v[40:43], v[84:87], v[64:67]
    s_waitcnt lgkmcnt(4)
    v_mfma_f32_16x16x32_bf16 v[68:71], v[44:47], v[84:87], v[68:71]
    s_waitcnt lgkmcnt(2)
    v_mfma_f32_16x16x32_bf16 v[72:75], v[48:51], v[84:87], v[72:75]
    s_waitcnt lgkmcnt(0)
    v_mfma_f32_16x16x32_bf16 v[76:79], v[52:55], v[84:87], v[76:79]
    s_nop 3
    v_cndmask_b32 v56, v64, v68, s[90:91]
    v_cndmask_b32 v57, v65, v69, s[90:91]
    v_cndmask_b32 v58, v66, v70, s[90:91]
    v_cndmask_b32 v59, v67, v71, s[90:91]
    v_cndmask_b32 v56, v56, v72, s[92:93]
    v_cndmask_b32 v57, v57, v73, s[92:93]
    v_cndmask_b32 v58, v58, v74, s[92:93]
    v_cndmask_b32 v59, v59, v75, s[92:93]
    v_cndmask_b32 v56, v56, v76, s[94:95]
    v_cndmask_b32 v57, v57, v77, s[94:95]
    v_cndmask_b32 v58, v58, v78, s[94:95]
    v_cndmask_b32 v59, v59, v79, s[94:95]
    v_bfi_b32 v56, s37, v11, v56
    v_bfi_b32 v57, s37, v11, v57
    v_bfi_b32 v58, s37, v11, v58
    v_bfi_b32 v59, s37, v11, v59
    ds_write_b128 v13, v[56:59]
    ds_write_b32 v17, v10 offset:24
L_qk:
    s_lshr_b32 s6, s5, 3
    s_and_b32 s7, s5, 7
    v_lshrrev_b32 v8, 4, v0
    v_and_b32 v12, 15, v0
    v_xor_b32 v20, v8, v12
    v_lshlrev_b32 v20, 4, v20
    v_lshl_add_u32 v20, v12, 8, v20
    s_lshl_b32 s39, s3, 13
    v_add_u32 v20, s39, v20
    v_xor_b32 v21, 64, v20
    v_xor_b32 v22, 128, v20
    v_xor_b32 v23, 192, v20
    v_lshrrev_b32 v13, 5, v0
    v_and_b32 v14, 31, v0
    v_lshlrev_b32 v24, 14, v13
    v_lshl_add_u32 v24, v14, 4, v24
L_pad5:
    s_cbranch_execz L_pad6
    s_lshl_b32 s58, s4, 15
    s_lshl_b32 s59, s6, 11
    s_add_u32 s58, s58, s59
    s_lshl_b32 s59, s3, 9
    s_add_u32 s65, s58, s59
    s_add_u32 s65, s65, 32768
    v_lshlrev_b32 v25, 2, v13
    v_and_b32 v15, 16, v0
    v_lshl_add_u32 v25, v15, 3, v25
    v_and_b32 v15, 12, v0
    v_lshl_add_u32 v25, v15, 1, v25
    v_and_b32 v15, 3, v0
    v_lshl_add_u32 v25, v15, 5, v25
    s_mul_i32 s39, s3, 320
    s_add_u32 s38, s39, 119040
    v_add_u32 v25, s38, v25
    v_bfe_u32 v16, v0, 2, 2
    v_mul_u32_u24 v26, 320, v16
    v_lshl_add_u32 v26, v8, 4, v26
    v_add_u32 v26, 119040, v26
    v_lshlrev_b32 v29, 4, v16
    v_add_u32 v29, 128768, v29
    s_lshl_b32 s38, s3, 2
    v_add_u32 v27, s38, v29
    v_lshlrev_b32 v28, 6, v16
    v_lshl_add_u32 v28, v8, 4, v28
    s_lshl_b32 s38, s3, 8
    s_add_u32 s38, s38, 120320
    v_add_u32 v28, s38, v28
    v_lshlrev_b32 v30, 9, v16
    s_lshl_b32 s67, s4, 7
    s_add_u32 s67, s67, s5
    s_lshl_b32 s67, s67, 4
    s_add_u32 s67, s67, 2113536
    v_mov_b32 v32, 0x3f803f80
    v_mov_b32 v33, 0x3f803f80
    v_mov_b32 v34, 0x3f803f80
    v_mov_b32 v35, 0x3f803f80
    s_mov_b32 s66, 0x3fb8aa3b
    s_mov_b32 s38, 0x3db504f3
    v_mov_b32 v108, s38
    v_mov_b32 v109, s38
    s_mov_b32 s57, 0x11111111
    s_lshl_b32 s56, s4, 2
    s_add_u32 s56, s56, s6
    v_lshlrev_b32 v103, 13, v13
    v_lshl_add_u32 v103, v14, 4, v103
    s_lshl_b32 s61, s56, 14
    s_add_u32 s61, s61, s59
    s_add_u32 s61, s61, 524288
    s_add_u32 s64, s61, 4096
    v_lshl_add_u32 v104, v13, 2, v15
    v_lshlrev_b32 v104, 4, v104
    s_lshl_b32 s60, s56, 2
    s_add_u32 s60, s60, s3
    s_lshl_b32 s60, s60, 7
    s_add_u32 s60, s60, 2113536
    v_lshlrev_b32 v102, 2, v13
    v_lshl_add_u32 v102, v14, 3, v102
    s_add_u32 s39, s39, 129088
    v_add_u32 v102, s39, v102
    v_mul_u32_u24 v101, 320, v15
    v_lshl_add_u32 v101, v8, 4, v101
    v_add_u32 v101, 129088, v101
    s_lshl_b32 s39, s3, 5
    v_xor_b32 v107, s39, v4
    v_lshlrev_b32 v105, 4, v0
    v_mov_b32 v110, s36
    v_bfe_u32 v111, v110, 20, 10
    v_bfe_u32 v110, v110, 10, 10
    s_xor_b32 s92, s7, 4
    s_lshl_b32 s62, s92, 17
    s_lshr_b32 s39, s56, 3
    s_lshl_b32 s39, s39, 14
    s_add_u32 s62, s62, s39
    s_and_b32 s39, s56, 7
    s_lshl_b32 s39, s39, 10
    s_add_u32 s62, s62, s39
    s_add_u32 s62, s62, 1048576
    s_lshl_b32 s39, s3, 8
    s_add_u32 s62, s62, s39
L_qw:
    s_sleep 1
    ds_read_b32 v12, v17 offset:20
    s_add_u32 s63, s63, 1
    s_cmp_gt_u32 s63, 4194304
    s_cbranch_scc1 L_qwok
    s_waitcnt lgkmcnt(0)
    v_cmp_eq_u32 vcc, 0, v12
    s_cbranch_vccnz L_qw
L_qwok:
L_kw:
    s_sleep 1
    ds_read_b32 v12, v9 offset:112
    s_add_u32 s63, s63, 1
    s_cmp_gt_u32 s63, 4194304
    s_cbranch_scc1 L_kwok
    s_waitcnt lgkmcnt(0)
    v_cmp_eq_u32 vcc, 0, v12
    s_cbranch_vccnz L_kw
L_kwok:
    s_mov_b32 s97, 0
    s_mov_b32 s58, s65
    s_add_u32 s59, s58, 8192
    buffer_load_dwordx4 v[36:39], v24, s[48:51], s58 offen sc1
    buffer_load_dwordx4 v[40:43], v24, s[48:51], s59 offen sc1
L_kv2:
    s_sleep 1
    ds_read_b32 v12, v9 offset:96
    s_add_u32 s63, s63, 1
    s_cmp_gt_u32 s63, 4194304
    s_cbranch_scc1 L_kv2ok
    s_waitcnt lgkmcnt(0)
    v_cmp_eq_u32 vcc, 0, v12
    s_cbranch_vccnz L_kv2
L_kv2ok:
    ds_read_b128 v[48:51], v20 offset:0
    ds_read_b128 v[52:55], v21 offset:0
    ds_read_b128 v[56:59], v22 offset:0
    ds_read_b128 v[60:63], v23 offset:0
    ds_read_b128 v[64:67], v20 offset:4096
    ds_read_b128 v[68:71], v21 offset:4096
    ds_read_b128 v[72:75], v22 offset:4096
    ds_read_b128 v[76:79], v23 offset:4096
L_qc:
    s_waitcnt vmcnt(0)
    v_bitop3_b32 v44, v36, v37, v11 bitop3:0x7e
    v_bitop3_b32 v45, v38, v39, v11 bitop3:0x7e
    v_bitop3_b32 v46, v40, v41, v11 bitop3:0x7e
    v_bitop3_b32 v47, v42, v43, v11 bitop3:0x7e
    v_or3_b32 v44, v44, v45, v46
    v_or_b32 v44, v44, v47
    v_and_b32 v44, 0x3ff, v44
    v_cmp_ne_u32 vcc, 0, v44
    s_cbranch_vccz L_qok
    s_add_u32 s97, s97, 1
    s_cmp_gt_u32 s97, 262144
    s_cbranch_scc1 L_qok
    buffer_load_dwordx4 v[36:39], v24, s[48:51], s58 offen sc1
    buffer_load_dwordx4 v[40:43], v24, s[48:51], s59 offen sc1
    s_branch L_qc
L_qok:
    v_and_b32 v36, s98, v36
    v_and_b32 v37, s98, v37
    v_and_b32 v38, s98, v38
    v_and_b32 v39, s98, v39
    v_and_b32 v40, s98, v40
    v_and_b32 v41, s98, v41
    v_and_b32 v42, s98, v42
    v_and_b32 v43, s98, v43
    v_pk_add_f32 v[36:37], v[36:37], v[40:41]
    v_pk_add_f32 v[38:39], v[38:39], v[42:43]
    s_nop 1
    v_permlane32_swap_b32 v36, v38
    v_permlane32_swap_b32 v37, v39
    v_pk_add_f32 v[36:37], v[36:37], v[38:39]
    v_cvt_pk_bf16_f32 v36, v36, v37
    ds_write_b32 v25, v36
    ds_write_b32 v9, v10 offset:48
L_qx:
    ds_read_b128 v[36:39], v17 offset:48
    ds_read_b128 v[80:83], v26 offset:0
    ds_read_b128 v[84:87], v26 offset:64
    ds_read_b128 v[88:91], v26 offset:128
    ds_read_b128 v[92:95], v26 offset:192
    s_add_u32 s63, s63, 1
    s_cmp_gt_u32 s63, 4194304
    s_cbranch_scc1 L_qxok
    s_waitcnt lgkmcnt(4)
    v_and_b32 v36, v36, v37
    v_and_b32 v38, v38, v39
    v_and_b32 v36, v36, v38
    v_cmp_eq_u32 vcc, 0, v36
    s_cbranch_vccnz L_qx
L_qxok:
    s_waitcnt lgkmcnt(3)
    v_mfma_f32_16x16x32_bf16 v[36:39], v[48:51], v[80:83], 0
    v_mfma_f32_16x16x32_bf16 v[40:43], v[64:67], v[80:83], 0
    s_waitcnt lgkmcnt(2)
    v_mfma_f32_16x16x32_bf16 v[36:39], v[52:55], v[84:87], v[36:39]
    v_mfma_f32_16x16x32_bf16 v[40:43], v[68:71], v[84:87], v[40:43]
    s_waitcnt lgkmcnt(1)
    v_mfma_f32_16x16x32_bf16 v[36:39], v[56:59], v[88:91], v[36:39]
    v_mfma_f32_16x16x32_bf16 v[40:43], v[72:75], v[88:91], v[40:43]
    s_waitcnt lgkmcnt(0)
    v_mfma_f32_16x16x32_bf16 v[36:39], v[60:63], v[92:95], v[36:39]
L_pad6:
    s_cbranch_execz L_pad7
    v_mfma_f32_16x16x32_bf16 v[40:43], v[76:79], v[92:95], v[40:43]
    s_nop 6
    v_cvt_pk_bf16_f32 v48, v36, v37
    v_cvt_pk_bf16_f32 v49, v38, v39
    v_cvt_pk_bf16_f32 v50, v40, v41
    v_cvt_pk_bf16_f32 v51, v42, v43
    v_lshlrev_b32 v36, 16, v48
    v_and_b32 v37, 0xffff0000, v48
    v_lshlrev_b32 v38, 16, v49
    v_and_b32 v39, 0xffff0000, v49
    v_lshlrev_b32 v40, 16, v50
    v_and_b32 v41, 0xffff0000, v50
    v_lshlrev_b32 v42, 16, v51
    v_and_b32 v43, 0xffff0000, v51
    v_pk_mul_f32 v[36:37], v[36:37], v[108:109]
    v_pk_mul_f32 v[38:39], v[38:39], v[108:109]
    v_pk_mul_f32 v[40:41], v[40:41], v[108:109]
    v_pk_mul_f32 v[42:43], v[42:43], v[108:109]
    v_cvt_pk_bf16_f32 v48, v36, v37
    v_cvt_pk_bf16_f32 v49, v38, v39
    v_cvt_pk_bf16_f32 v50, v40, v41
    v_cvt_pk_bf16_f32 v51, v42, v43
    v_lshlrev_b32 v36, 16, v48
    v_and_b32 v37, 0xffff0000, v48
    v_lshlrev_b32 v38, 16, v49
    v_and_b32 v39, 0xffff0000, v49
    v_lshlrev_b32 v40, 16, v50
    v_and_b32 v41, 0xffff0000, v50
    v_lshlrev_b32 v42, 16, v51
    v_and_b32 v43, 0xffff0000, v51
    v_max3_f32 v44, v36, v37, v38
    v_max3_f32 v45, v39, v40, v41
    v_max3_f32 v44, v44, v42, v43
    v_max_f32 v44, v44, v45
    v_mov_b32 v45, v44
    s_nop 1
    v_permlane32_swap_b32 v44, v45
    v_max_f32 v44, v44, v45
    v_mov_b32 v45, v44
    s_nop 1
    v_permlane16_swap_b32 v44, v45
    v_max_f32 v44, v44, v45
    v_mul_f32 v44, s66, v44
    s_mov_b64 exec, 0x1111
    ds_write_b32 v27, v44
    s_mov_b64 exec, -1
L_mx:
    ds_read_b128 v[48:51], v29
    s_add_u32 s63, s63, 1
    s_cmp_gt_u32 s63, 4194304
    s_cbranch_scc1 L_mxok
    s_waitcnt lgkmcnt(0)
    v_max_u32 v45, v48, v49
    v_max3_u32 v45, v45, v50, v51
    v_cmp_eq_u32 vcc, -1, v45
    s_cbranch_vccnz L_mx
L_mxok:
    v_max3_f32 v44, v48, v49, v50
    v_max_f32 v44, v44, v51
    v_and_b32 v44, s98, v44
    v_fma_f32 v36, v36, s66, -v44
    v_fma_f32 v37, v37, s66, -v44
    v_fma_f32 v38, v38, s66, -v44
    v_fma_f32 v39, v39, s66, -v44
    v_fma_f32 v40, v40, s66, -v44
    v_fma_f32 v41, v41, s66, -v44
    v_fma_f32 v42, v42, s66, -v44
    v_fma_f32 v43, v43, s66, -v44
    v_exp_f32 v36, v36
    v_exp_f32 v37, v37
    v_exp_f32 v38, v38
    v_exp_f32 v39, v39
    v_exp_f32 v40, v40
    v_exp_f32 v41, v41
    v_exp_f32 v42, v42
    v_exp_f32 v43, v43
    v_cvt_pk_bf16_f32 v36, v36, v37
    v_cvt_pk_bf16_f32 v37, v38, v39
    v_cvt_pk_bf16_f32 v38, v40, v41
    v_cvt_pk_bf16_f32 v39, v42, v43
    s_nop 1
    v_mfma_f32_16x16x32_bf16 v[40:43], v[32:35], v[36:39], 0
    s_mov_b32 exec_lo, s57
    s_mov_b32 exec_hi, s57
    ds_write_b128 v28, v[36:39]
    s_mov_b64 exec, 0x1111
    s_nop 3
    ds_write_b32 v27, v40 offset:64
    s_mov_b64 exec, -1
L_xw:
    ds_read_b32 v12, v17 offset:16
    s_add_u32 s63, s63, 1
    s_cmp_gt_u32 s63, 4194304
    s_cbranch_scc1 L_xwok
    s_waitcnt lgkmcnt(0)
    v_cmp_eq_u32 vcc, 0, v12
    s_cbranch_vccnz L_xw
L_xwok:
    v_readfirstlane_b32 s56, v12
    ds_write_b32 v9, v10 offset:80
    s_cmp_eq_u32 s3, 0
    s_cbranch_scc0 L_wo_b3
L_lx:
    ds_read_b128 v[36:39], v17 offset:80
    ds_read_b128 v[40:43], v29 offset:64
    s_add_u32 s63, s63, 1
    s_cmp_gt_u32 s63, 4194304
    s_cbranch_scc1 L_lxok
    s_waitcnt lgkmcnt(0)
    v_and_b32 v36, v36, v37
    v_and_b32 v38, v38, v39
    v_and_b32 v36, v36, v38
    v_cmp_eq_u32 vcc, 0, v36
    s_cbranch_vccnz L_lx
L_lxok:
    v_pk_add_f32 v[40:41], v[40:41], v[42:43]
    v_mov_b32 v46, v11
    v_mov_b32 v47, v11
    v_or_b32 v44, v44, v11
    v_add_f32 v45, v40, v41
    s_mov_b64 exec, 0x1111
    v_bfi_b32 v45, s37, v11, v45
    s_cmp_eq_u32 s56, 1
    s_cbranch_scc0 L_mlr
    buffer_store_dwordx4 v[44:47], v30, s[48:51], s67 offen
    s_branch L_ml1
L_mlr:
    buffer_store_dwordx4 v[44:47], v30, s[48:51], s67 offen sc1
L_ml1:
    s_mov_b64 exec, -1
L_wo_b3:
    v_mov_b32 v106, 128896
L_wow:
    s_sleep 1
    ds_read_b128 v[36:39], v106 offset:128
    s_add_u32 s63, s63, 1
    s_cmp_gt_u32 s63, 4194304
    s_cbranch_scc1 L_wowok
    s_waitcnt lgkmcnt(0)
    v_and_b32 v36, v36, v37
    v_and_b32 v38, v38, v39
    v_and_b32 v36, v36, v38
    v_cmp_eq_u32 vcc, 0, v36
    s_cbranch_vccnz L_wow
L_wowok:
    ds_read_b64_tr_b16 v[16:17], v107 offset:16384
    ds_read_b64_tr_b16 v[18:19], v107 offset:18432
    ds_read_b64_tr_b16 v[20:21], v107 offset:20480
    ds_read_b64_tr_b16 v[22:23], v107 offset:22528
    ds_read_b64_tr_b16 v[24:25], v107 offset:24576
    ds_read_b64_tr_b16 v[26:27], v107 offset:26624
    ds_read_b64_tr_b16 v[28:29], v107 offset:28672
    ds_read_b64_tr_b16 v[30:31], v107 offset:30720
    s_waitcnt lgkmcnt(0)
    s_barrier
    buffer_load_dwordx4 v[32:35], v104, s[48:51], s60 offen sc1
L_wt:
    ds_read_b128 v[36:39], v106 offset:160
    ds_read_b32 v60, v106 offset:28
    s_add_u32 s63, s63, 1
    s_cmp_gt_u32 s63, 4194304
    s_cbranch_scc1 L_wtok
    s_waitcnt lgkmcnt(0)
    v_and_b32 v36, v36, v37
    v_and_b32 v38, v38, v39
    v_and_b32 v36, v36, v38
    v_cmp_eq_u32 vcc, 0, v36
    s_cbranch_vccnz L_wt
L_wtok:
    s_setprio 2
    s_mov_b32 s97, 0
    buffer_load_dwordx4 v[40:43], v103, s[48:51], s61 offen sc1
    buffer_load_dwordx4 v[44:47], v103, s[48:51], s61 offen offset:2048 sc1
    buffer_load_dwordx4 v[48:51], v103, s[48:51], s64 offen sc1
    buffer_load_dwordx4 v[52:55], v103, s[48:51], s64 offen offset:2048 sc1
    v_readfirstlane_b32 s38, v60
    s_nop 2
    s_lshr_b32 s39, s38, s92
    s_and_b32 s39, s39, 1
    s_lshl_b32 s39, s39, 13
    s_add_u32 s62, s62, s39
    s_waitcnt vmcnt(4)
    v_bitop3_b32 v56, v32, v33, v11 bitop3:0x7e
    v_bitop3_b32 v57, v34, v35, v11 bitop3:0x7e
    v_or_b32 v56, v56, v57
    v_and_b32 v56, 0x3ff, v56
    v_cmp_ne_u32 vcc, 0, v56
    s_cbranch_vccz L_o2
L_o:
    buffer_load_dwordx4 v[32:35], v104, s[48:51], s60 offen sc1
L_pad7:
    s_cbranch_execz L_pad8
    s_add_u32 s97, s97, 1
    s_cmp_gt_u32 s97, 262144
    s_cbranch_scc1 L_o2
    s_waitcnt vmcnt(0)
    v_bitop3_b32 v56, v32, v33, v11 bitop3:0x7e
    v_bitop3_b32 v57, v34, v35, v11 bitop3:0x7e
    v_or_b32 v56, v56, v57
    v_and_b32 v56, 0x3ff, v56
    v_cmp_ne_u32 vcc, 0, v56
    s_cbranch_vccnz L_o
L_o2:
    v_and_b32 v32, s98, v32
    v_and_b32 v33, s98, v33
    s_nop 0
    v_max_f32_dpp v56, v32, v32 quad_perm:[1,0,3,2] row_mask:0xf bank_mask:0xf
    s_nop 1
    v_max_f32_dpp v56, v56, v56 quad_perm:[2,3,0,1] row_mask:0xf bank_mask:0xf
    v_mov_b32 v57, v56
    s_nop 1
    v_permlane32_swap_b32 v56, v57
    v_max_f32 v56, v56, v57
    v_sub_f32 v32, v32, v56
    v_exp_f32 v32, v32
    s_nop 0
    v_mul_f32 v57, v32, v33
    s_nop 1
    v_add_f32_dpp v57, v57, v57 quad_perm:[1,0,3,2] row_mask:0xf bank_mask:0xf
    s_nop 1
    v_add_f32_dpp v57, v57, v57 quad_perm:[2,3,0,1] row_mask:0xf bank_mask:0xf
    v_mov_b32 v58, v57
    s_nop 1
    v_permlane32_swap_b32 v57, v58
    v_add_f32 v57, v57, v58
    v_rcp_f32 v57, v57
    s_nop 0
    v_mul_f32 v32, v32, v57
    s_nop 1
    v_mov_b32_dpp v64, v32 quad_perm:[0,0,0,0] row_mask:0xf bank_mask:0xf
    v_mov_b32_dpp v66, v32 quad_perm:[1,1,1,1] row_mask:0xf bank_mask:0xf
    v_mov_b32_dpp v68, v32 quad_perm:[2,2,2,2] row_mask:0xf bank_mask:0xf
    v_mov_b32_dpp v70, v32 quad_perm:[3,3,3,3] row_mask:0xf bank_mask:0xf
    v_mov_b32 v65, v64
    v_mov_b32 v67, v66
    v_mov_b32 v69, v68
    v_mov_b32 v71, v70
    s_mov_b32 s97, 0
L_o4:
    s_waitcnt vmcnt(0)
    v_xor_b32 v40, v11, v40
    v_xor_b32 v41, v11, v41
    v_xor_b32 v42, v11, v42
    v_xor_b32 v43, v11, v43
    v_xor_b32 v44, v11, v44
    v_xor_b32 v45, v11, v45
    v_xor_b32 v46, v11, v46
    v_xor_b32 v47, v11, v47
    v_xor_b32 v48, v11, v48
    v_xor_b32 v49, v11, v49
    v_xor_b32 v50, v11, v50
    v_xor_b32 v51, v11, v51
    v_xor_b32 v52, v11, v52
    v_xor_b32 v53, v11, v53
    v_xor_b32 v54, v11, v54
    v_xor_b32 v55, v11, v55
    v_or3_b32 v56, v40, v41, v42
    v_or3_b32 v57, v43, v44, v45
    v_or3_b32 v58, v46, v47, v48
    v_or3_b32 v59, v49, v50, v51
    v_or3_b32 v36, v52, v53, v54
    v_or3_b32 v37, v56, v57, v58
    v_or3_b32 v38, v59, v36, v55
    v_or_b32 v39, v37, v38
    v_and_b32 v39, 0x3ff, v39
    v_cmp_ne_u32 vcc, 0, v39
    s_cbranch_vccnz L_o3
    s_mov_b64 exec, -1
L_ook:
    v_pk_mul_f32 v[36:37], v[64:65], v[40:41]
    v_pk_mul_f32 v[38:39], v[64:65], v[42:43]
    v_pk_fma_f32 v[36:37], v[66:67], v[44:45], v[36:37]
    v_pk_fma_f32 v[38:39], v[66:67], v[46:47], v[38:39]
    v_pk_fma_f32 v[36:37], v[68:69], v[48:49], v[36:37]
    v_pk_fma_f32 v[38:39], v[68:69], v[50:51], v[38:39]
    v_pk_fma_f32 v[36:37], v[70:71], v[52:53], v[36:37]
    v_pk_fma_f32 v[38:39], v[70:71], v[54:55], v[38:39]
    s_nop 1
    v_permlane32_swap_b32 v36, v38
    v_permlane32_swap_b32 v37, v39
    v_pk_add_f32 v[36:37], v[36:37], v[38:39]
    v_cvt_pk_bf16_f32 v36, v36, v37
    ds_write_b32 v102, v36
    s_waitcnt lgkmcnt(0)
    s_barrier
    ds_read_b128 v[40:43], v101 offset:0
    ds_read_b128 v[44:47], v101 offset:64
    ds_read_b128 v[48:51], v101 offset:128
    ds_read_b128 v[52:55], v101 offset:192
    s_waitcnt lgkmcnt(3)
    v_mfma_f32_16x16x32_bf16 v[32:35], v[40:43], v[16:19], 0
    s_waitcnt lgkmcnt(2)
    v_mfma_f32_16x16x32_bf16 v[32:35], v[44:47], v[20:23], v[32:35]
    s_waitcnt lgkmcnt(1)
    v_mfma_f32_16x16x32_bf16 v[32:35], v[48:51], v[24:27], v[32:35]
    s_waitcnt lgkmcnt(0)
    v_mfma_f32_16x16x32_bf16 v[32:35], v[52:55], v[28:31], v[32:35]
    s_mov_b64 exec, 0xffff
    s_nop 6
    v_bfi_b32 v32, s37, v11, v32
    v_bfi_b32 v33, s37, v110, v33
    v_bfi_b32 v34, s37, v111, v34
    v_bfi_b32 v35, s37, v11, v35
    buffer_store_dwordx4 v[32:35], v105, s[48:51], s62 offen sc1
    s_endpgm
L_o3:
    s_add_u32 s97, s97, 1
    s_cmp_gt_u32 s97, 262144
    s_cbranch_scc1 L_ook
    s_mov_b64 exec, vcc
    buffer_load_dwordx4 v[40:43], v103, s[48:51], s61 offen sc1
    buffer_load_dwordx4 v[44:47], v103, s[48:51], s61 offen offset:2048 sc1
    buffer_load_dwordx4 v[48:51], v103, s[48:51], s64 offen sc1
    buffer_load_dwordx4 v[52:55], v103, s[48:51], s64 offen offset:2048 sc1
    s_branch L_o4
L_w8:
    s_lshr_b32 s7, s5, 3
    s_mul_i32 s68, s4, 3
    s_min_u32 s69, s4, 4
    s_add_u32 s68, s68, s69
    s_add_u32 s68, s68, s7
    s_cmp_lt_u32 s4, 4
    s_cselect_b32 s69, 4, 3
    s_cmp_lt_u32 s7, s69
    s_cselect_b32 s69, 1, 0
    s_mov_b32 s44, s22
    s_mov_b32 s45, s23
    s_mov_b32 s46, 0xe00
    s_mov_b32 s47, 0x20000
    s_and_b32 s6, s5, 7
    v_lshrrev_b32 v12, 4, v0
    v_and_b32 v13, 3, v0
    v_bfe_u32 v14, v0, 2, 2
    v_cmp_eq_u32 s[90:91], 1, v12
    v_cmp_eq_u32 s[92:93], 2, v12
    v_cmp_eq_u32 s[94:95], 3, v12
    v_lshlrev_b32 v8, 5, v13
    v_lshl_add_u32 v8, v14, 3, v8
    s_lshl_b32 s57, s68, 7
    v_mul_u32_u24 v9, 192, v12
    v_lshl_add_u32 v9, v14, 4, v9
    v_and_b32 v14, 2, v0
    v_lshl_add_u32 v9, v14, 5, v9
    v_cmp_ne_u32 s[60:61], 0, v14
    v_and_b32 v15, 1, v0
    v_lshl_add_u32 v9, v15, 3, v9
    v_add_u32 v9, 130368, v9
    v_mul_u32_u24 v19, 192, v13
    v_lshl_add_u32 v19, v12, 4, v19
    v_add_u32 v19, 130368, v19
    s_lshl_b32 s58, s68, 13
    s_add_u32 s58, s58, 294912
    s_add_u32 s59, s58, 4096
    v_lshlrev_b32 v10, 4, v0
    s_add_u32 s39, s4, 24
    s_cmp_eq_u32 s69, 0
    s_cselect_b32 s39, s39, s68
    s_add_u32 s64, s39, 32
    s_xor_b32 s67, s6, 2
    s_lshl_b32 s62, s67, 17
    s_lshr_b32 s39, s64, 3
    s_lshl_b32 s39, s39, 14
    s_add_u32 s62, s62, s39
    s_and_b32 s39, s64, 7
    s_lshl_b32 s39, s39, 10
    s_add_u32 s62, s62, s39
    s_add_u32 s62, s62, 1048576
    v_lshrrev_b32 v3, 4, v0
    v_lshlrev_b32 v3, 14, v3
    v_bfe_u32 v1, v0, 1, 3
    v_lshl_add_u32 v3, v1, 10, v3
    v_lshl_add_u32 v3, v15, 4, v3
    s_lshl_b32 s64, s4, 17
    s_add_u32 s64, s64, 1048576
    s_lshl_b32 s39, s5, 5
    s_add_u32 s64, s64, s39
    v_and_b32 v16, 1, v12
    v_add_u32 v16, v16, v14
L_pad8:
    s_cbranch_execz L_pad9
    v_lshlrev_b32 v1, 1, v15
    v_lshl_add_u32 v16, v16, 10, v1
    s_lshl_b32 s66, s4, 7
    s_lshl_b32 s39, s5, 2
    s_add_u32 s66, s66, s39
    buffer_load_dwordx2 v[20:21], v8, s[44:47], s57 offen
    s_mov_b32 s44, s26
    s_mov_b32 s45, s27
    s_mov_b32 s46, 0x400
    s_mov_b32 s47, 0x20000
    buffer_load_ushort v17, v16, s[52:55], s66 offen
    buffer_load_ushort v18, v1, s[44:47], s66 offen
    s_mov_b32 s40, s28
    s_mov_b32 s41, s29
    s_mov_b32 s42, 0x1000
    s_mov_b32 s43, 0x20000
    buffer_load_ushort v124, v16, s[40:43], s66 offen nt
    s_mov_b32 s57, 0xbfb8aa3b
    v_mov_b32 v2, 128896
    v_mov_b32 v116, s36
    v_bfe_u32 v117, v116, 20, 10
    v_bfe_u32 v116, v116, 10, 10
    v_mov_b32 v96, v11
    v_mov_b32 v97, v116
    v_mov_b32 v98, v117
    v_mov_b32 v99, v11
L_hg:
    s_sleep 1
    ds_read_b32 v12, v2 offset:48
    s_add_u32 s63, s63, 1
    s_cmp_gt_u32 s63, 4194304
    s_cbranch_scc1 L_hgok
    s_waitcnt lgkmcnt(0)
    v_cmp_eq_u32 vcc, 0, v12
    s_cbranch_vccnz L_hg
L_hgok:
    s_mov_b32 s97, 0
    s_cmp_eq_u32 s69, 0
    s_cbranch_scc1 L_noh
    buffer_load_dwordx4 v[56:59], v10, s[48:51], s58 offen offset:0 sc1
    buffer_load_dwordx4 v[60:63], v10, s[48:51], s58 offen offset:1024 sc1
    buffer_load_dwordx4 v[64:67], v10, s[48:51], s58 offen offset:2048 sc1
    buffer_load_dwordx4 v[68:71], v10, s[48:51], s58 offen offset:3072 sc1
    buffer_load_dwordx4 v[72:75], v10, s[48:51], s59 offen offset:0 sc1
    buffer_load_dwordx4 v[76:79], v10, s[48:51], s59 offen offset:1024 sc1
    buffer_load_dwordx4 v[80:83], v10, s[48:51], s59 offen offset:2048 sc1
    buffer_load_dwordx4 v[84:87], v10, s[48:51], s59 offen offset:3072 sc1
L_noh:
    s_lshr_b32 s39, s96, s67
    s_and_b32 s39, s39, 1
    s_lshl_b32 s39, s39, 13
    s_add_u32 s62, s62, s39
    s_lshr_b32 s39, s96, s4
    s_and_b32 s39, s39, 1
    s_lshl_b32 s39, s39, 13
    s_add_u32 s64, s64, s39
    s_waitcnt lgkmcnt(0)
    s_add_u32 s65, s64, 65536
    s_cmp_eq_u32 s69, 0
    s_barrier
    s_cbranch_scc1 L_w8_fin
L_h:
    s_waitcnt vmcnt(0)
    v_lshlrev_b32 v88, 16, v20
    v_and_b32 v89, 0xffff0000, v20
    v_lshlrev_b32 v90, 16, v21
    v_and_b32 v91, 0xffff0000, v21
    v_bitop3_b32 v100, v56, v57, v11 bitop3:0x7e
    v_bitop3_b32 v101, v58, v59, v11 bitop3:0x7e
    v_bitop3_b32 v102, v60, v61, v11 bitop3:0x7e
    v_bitop3_b32 v103, v62, v63, v11 bitop3:0x7e
    v_bitop3_b32 v104, v64, v65, v11 bitop3:0x7e
    v_bitop3_b32 v105, v66, v67, v11 bitop3:0x7e
    v_bitop3_b32 v106, v68, v69, v11 bitop3:0x7e
    v_bitop3_b32 v107, v70, v71, v11 bitop3:0x7e
    v_bitop3_b32 v108, v72, v73, v11 bitop3:0x7e
    v_bitop3_b32 v109, v74, v75, v11 bitop3:0x7e
    v_bitop3_b32 v110, v76, v77, v11 bitop3:0x7e
    v_bitop3_b32 v111, v78, v79, v11 bitop3:0x7e
    v_bitop3_b32 v112, v80, v81, v11 bitop3:0x7e
    v_bitop3_b32 v113, v82, v83, v11 bitop3:0x7e
    v_bitop3_b32 v114, v84, v85, v11 bitop3:0x7e
    v_bitop3_b32 v115, v86, v87, v11 bitop3:0x7e
    v_or3_b32 v100, v100, v101, v102
    v_or3_b32 v103, v103, v104, v105
    v_or3_b32 v106, v106, v107, v108
    v_or3_b32 v109, v109, v110, v111
    v_or3_b32 v112, v112, v113, v114
    v_or3_b32 v100, v100, v103, v106
    v_or3_b32 v109, v109, v112, v115
    v_or_b32 v100, v100, v109
    v_and_b32 v100, 0x3ff, v100
    v_cmp_ne_u32 vcc, 0, v100
    s_cbranch_vccz L_hok
    s_add_u32 s97, s97, 1
    s_cmp_gt_u32 s97, 262144
    s_cbranch_scc1 L_hok
    buffer_load_dwordx4 v[56:59], v10, s[48:51], s58 offen offset:0 sc1
    buffer_load_dwordx4 v[60:63], v10, s[48:51], s58 offen offset:1024 sc1
    buffer_load_dwordx4 v[64:67], v10, s[48:51], s58 offen offset:2048 sc1
    buffer_load_dwordx4 v[68:71], v10, s[48:51], s58 offen offset:3072 sc1
    buffer_load_dwordx4 v[72:75], v10, s[48:51], s59 offen offset:0 sc1
    buffer_load_dwordx4 v[76:79], v10, s[48:51], s59 offen offset:1024 sc1
    buffer_load_dwordx4 v[80:83], v10, s[48:51], s59 offen offset:2048 sc1
    buffer_load_dwordx4 v[84:87], v10, s[48:51], s59 offen offset:3072 sc1
    s_branch L_h
L_hok:
    v_and_b32 v56, s98, v56
    v_and_b32 v57, s98, v57
    v_and_b32 v58, s98, v58
    v_and_b32 v59, s98, v59
    v_and_b32 v60, s98, v60
    v_and_b32 v61, s98, v61
    v_and_b32 v62, s98, v62
    v_and_b32 v63, s98, v63
    v_and_b32 v64, s98, v64
    v_and_b32 v65, s98, v65
    v_and_b32 v66, s98, v66
    v_and_b32 v67, s98, v67
    v_and_b32 v68, s98, v68
    v_and_b32 v69, s98, v69
    v_and_b32 v70, s98, v70
    v_and_b32 v71, s98, v71
    v_and_b32 v72, s98, v72
    v_and_b32 v73, s98, v73
    v_and_b32 v74, s98, v74
    v_and_b32 v75, s98, v75
    v_and_b32 v76, s98, v76
    v_and_b32 v77, s98, v77
    v_and_b32 v78, s98, v78
    v_and_b32 v79, s98, v79
    v_and_b32 v80, s98, v80
    v_and_b32 v81, s98, v81
    v_and_b32 v82, s98, v82
    v_and_b32 v83, s98, v83
    v_and_b32 v84, s98, v84
    v_and_b32 v85, s98, v85
    v_and_b32 v86, s98, v86
    v_and_b32 v87, s98, v87
    v_pk_add_f32 v[56:57], v[56:57], v[60:61]
    v_pk_add_f32 v[58:59], v[58:59], v[62:63]
    v_pk_add_f32 v[64:65], v[64:65], v[68:69]
    v_pk_add_f32 v[66:67], v[66:67], v[70:71]
    v_pk_add_f32 v[72:73], v[72:73], v[76:77]
    v_pk_add_f32 v[74:75], v[74:75], v[78:79]
    v_pk_add_f32 v[80:81], v[80:81], v[84:85]
    v_pk_add_f32 v[82:83], v[82:83], v[86:87]
    v_pk_add_f32 v[56:57], v[56:57], v[64:65]
    v_pk_add_f32 v[58:59], v[58:59], v[66:67]
    v_pk_add_f32 v[72:73], v[72:73], v[80:81]
    v_pk_add_f32 v[74:75], v[74:75], v[82:83]
    v_pk_add_f32 v[56:57], v[56:57], v[72:73]
    v_pk_add_f32 v[58:59], v[58:59], v[74:75]
    v_cvt_pk_bf16_f32 v60, v56, v57
    v_cvt_pk_bf16_f32 v61, v58, v59
    v_lshlrev_b32 v56, 16, v60
    v_and_b32 v57, 0xffff0000, v60
    v_lshlrev_b32 v58, 16, v61
    v_and_b32 v59, 0xffff0000, v61
    v_pk_add_f32 v[56:57], v[56:57], v[88:89]
    v_pk_add_f32 v[58:59], v[58:59], v[90:91]
    v_cvt_pk_bf16_f32 v60, v56, v57
    v_cvt_pk_bf16_f32 v61, v58, v59
    v_lshlrev_b32 v56, 16, v60
    v_and_b32 v57, 0xffff0000, v60
    v_lshlrev_b32 v58, 16, v61
    v_and_b32 v59, 0xffff0000, v61
    v_max_f32 v56, 0, v56
    v_max_f32 v57, 0, v57
    v_max_f32 v58, 0, v58
    v_max_f32 v59, 0, v59
    v_pk_mul_f32 v[56:57], v[56:57], v[56:57]
    v_pk_mul_f32 v[58:59], v[58:59], v[58:59]
    v_cvt_pk_bf16_f32 v60, v56, v57
L_pad9:
    s_cbranch_execz L_w3b
    v_cvt_pk_bf16_f32 v61, v58, v59
    ds_write_b64 v9, v[60:61]
    ds_read_b128 v[64:67], v19
    ds_read_b128 v[68:71], v19 offset:64
L_w2w:
    ds_read_b128 v[72:75], v2 offset:32
    s_add_u32 s63, s63, 1
    s_cmp_gt_u32 s63, 4194304
    s_cbranch_scc1 L_w2wok
    s_waitcnt lgkmcnt(0)
    v_and_b32 v72, v72, v73
    v_and_b32 v74, v74, v75
    v_and_b32 v72, v72, v74
    v_cmp_eq_u32 vcc, 0, v72
    s_cbranch_vccnz L_w2w
L_w2wok:
    ds_read_b64_tr_b16 v[24:25], v4 offset:40960
    ds_read_b64_tr_b16 v[26:27], v4 offset:43008
    ds_read_b64_tr_b16 v[28:29], v5 offset:40960
    ds_read_b64_tr_b16 v[30:31], v5 offset:43008
    ds_read_b64_tr_b16 v[32:33], v6 offset:40960
    ds_read_b64_tr_b16 v[34:35], v6 offset:43008
    ds_read_b64_tr_b16 v[36:37], v7 offset:40960
    ds_read_b64_tr_b16 v[38:39], v7 offset:43008
    ds_read_b64_tr_b16 v[40:41], v4 offset:45056
    ds_read_b64_tr_b16 v[42:43], v4 offset:47104
    ds_read_b64_tr_b16 v[44:45], v5 offset:45056
    ds_read_b64_tr_b16 v[46:47], v5 offset:47104
    ds_read_b64_tr_b16 v[48:49], v6 offset:45056
    ds_read_b64_tr_b16 v[50:51], v6 offset:47104
    ds_read_b64_tr_b16 v[52:53], v7 offset:45056
    ds_read_b64_tr_b16 v[54:55], v7 offset:47104
    s_waitcnt lgkmcnt(14)
    v_mfma_f32_16x16x32_bf16 v[72:75], v[64:67], v[24:27], 0
    s_waitcnt lgkmcnt(12)
    v_mfma_f32_16x16x32_bf16 v[76:79], v[64:67], v[28:31], 0
    s_waitcnt lgkmcnt(10)
    v_mfma_f32_16x16x32_bf16 v[80:83], v[64:67], v[32:35], 0
    s_waitcnt lgkmcnt(8)
    v_mfma_f32_16x16x32_bf16 v[84:87], v[64:67], v[36:39], 0
    s_waitcnt lgkmcnt(6)
    v_mfma_f32_16x16x32_bf16 v[72:75], v[68:71], v[40:43], v[72:75]
    s_waitcnt lgkmcnt(4)
    v_mfma_f32_16x16x32_bf16 v[76:79], v[68:71], v[44:47], v[76:79]
    s_waitcnt lgkmcnt(2)
    v_mfma_f32_16x16x32_bf16 v[80:83], v[68:71], v[48:51], v[80:83]
    s_waitcnt lgkmcnt(0)
    v_mfma_f32_16x16x32_bf16 v[84:87], v[68:71], v[52:55], v[84:87]
    s_nop 3
    v_cndmask_b32 v96, v72, v76, s[90:91]
    v_cndmask_b32 v97, v73, v77, s[90:91]
    v_cndmask_b32 v98, v74, v78, s[90:91]
    v_cndmask_b32 v99, v75, v79, s[90:91]
    v_cndmask_b32 v96, v96, v80, s[92:93]
    v_cndmask_b32 v97, v97, v81, s[92:93]
    v_cndmask_b32 v98, v98, v82, s[92:93]
    v_cndmask_b32 v99, v99, v83, s[92:93]
    v_cndmask_b32 v96, v96, v84, s[94:95]
    v_cndmask_b32 v97, v97, v85, s[94:95]
    v_cndmask_b32 v98, v98, v86, s[94:95]
    v_cndmask_b32 v99, v99, v87, s[94:95]
    v_bfi_b32 v96, s37, v11, v96
    v_bfi_b32 v97, s37, v116, v97
    v_bfi_b32 v98, s37, v117, v98
    v_bfi_b32 v99, s37, v11, v99
L_w8_fin:
    s_barrier
    buffer_store_dwordx4 v[96:99], v10, s[48:51], s62 offen sc1
    s_mov_b32 s97, 0
    s_waitcnt vmcnt(1)
    v_lshlrev_b32 v17, 16, v17
    v_lshlrev_b32 v18, 16, v18
    s_barrier
L_f:
    buffer_load_dwordx4 v[24:27], v3, s[48:51], s64 offen sc1
    buffer_load_dwordx4 v[40:43], v3, s[48:51], s65 offen sc1
    s_add_u32 s97, s97, 1
    s_cmp_gt_u32 s97, 262144
    s_cbranch_scc1 L_fok
    s_waitcnt vmcnt(0)
L_f2:
    v_xor_b32 v24, v11, v24
    v_xor_b32 v40, v11, v40
    v_xor_b32 v25, v116, v25
    v_xor_b32 v41, v116, v41
    v_xor_b32 v26, v117, v26
    v_xor_b32 v42, v117, v42
    v_xor_b32 v27, v11, v27
    v_xor_b32 v43, v11, v43
    v_or3_b32 v44, v24, v40, v25
    v_or3_b32 v45, v41, v26, v42
    v_or3_b32 v46, v44, v45, v27
    v_or_b32 v47, v46, v43
    v_and_b32 v47, 0x3ff, v47
    v_cmp_ne_u32 vcc, 0, v47
    s_cbranch_vccnz L_f
L_fok:
    v_permlane32_swap_b32 v24, v40
    v_permlane32_swap_b32 v25, v41
    v_permlane32_swap_b32 v26, v42
    v_permlane32_swap_b32 v27, v43
    v_pk_add_f32 v[24:25], v[24:25], v[40:41]
    v_pk_add_f32 v[26:27], v[26:27], v[42:43]
    s_nop 0
    v_permlane16_swap_b32 v24, v25
    v_permlane16_swap_b32 v26, v27
    v_add_f32 v24, v24, v25
    v_add_f32 v26, v26, v27
    s_nop 0
    v_add_f32_dpp v24, v24, v24 row_ror:8 row_mask:0xf bank_mask:0xf
    v_add_f32_dpp v26, v26, v26 row_ror:8 row_mask:0xf bank_mask:0xf
    s_nop 0
    v_add_f32_dpp v24, v24, v24 row_ror:4 row_mask:0xf bank_mask:0xf
    v_add_f32_dpp v26, v26, v26 row_ror:4 row_mask:0xf bank_mask:0xf
    s_nop 0
    v_add_f32_dpp v24, v24, v24 row_ror:2 row_mask:0xf bank_mask:0xf
    v_add_f32_dpp v26, v26, v26 row_ror:2 row_mask:0xf bank_mask:0xf
    v_cndmask_b32 v24, v24, v26, s[60:61]
    v_cvt_pk_bf16_f32 v24, v24, v24
    v_and_b32 v24, 0xffff0000, v24
    v_add_f32 v25, v24, v18
    v_cvt_pk_bf16_f32 v25, v25, v25
    v_and_b32 v25, 0xffff0000, v25
    v_mul_f32 v26, s57, v25
    v_exp_f32 v26, v26
    s_nop 0
    v_add_f32 v26, 1.0, v26
    v_rcp_f32 v26, v26
    s_nop 0
    v_mul_f32 v26, v25, v26
    v_cvt_pk_bf16_f32 v26, v26, v26
    v_and_b32 v26, 0xffff0000, v26
    s_nop 1
    v_permlane32_swap_b32 v26, v27
    s_mov_b32 exec_lo, 0x000f000f
    s_mov_b32 exec_hi, 0
    v_mul_f32 v24, v24, v27
    v_cvt_pk_bf16_f32 v24, v24, v24
    v_and_b32 v24, 0xffff0000, v24
    v_add_f32 v24, v24, v17
    v_cvt_pk_bf16_f32 v24, v24, v24
    buffer_store_short v24, v16, s[40:43], s66 offen
    s_cmp_eq_u32 s2, 0
    s_cbranch_scc0 L_end
    v_mov_b32 v24, s36
    v_mov_b32 v25, 0
    s_mov_b64 exec, 1
    buffer_store_dword v24, v25, s[48:51], 0 offen
L_end:
L_exit:
    s_endpgm
.fill (12288 - (. - recurrent_scan__sliding_block_cached__dense_activation_squared_relu__decode_kernel)) / 4, 4, 0xbf800000
.section .rodata,"a"
.p2align 6
.amdhsa_kernel recurrent_scan__sliding_block_cached__dense_activation_squared_relu__decode_kernel
  .amdhsa_next_free_vgpr 128
  .amdhsa_next_free_sgpr 100
  .amdhsa_accum_offset 128
  .amdhsa_group_segment_fixed_size 0
  .amdhsa_kernarg_size 104
  .amdhsa_user_sgpr_count 2
  .amdhsa_user_sgpr_kernarg_segment_ptr 1
  .amdhsa_system_sgpr_workgroup_id_x 1
.end_amdhsa_kernel
```
